```python
import torch

def _softmax(x, axis=-1):
    return torch.softmax(x, dim=axis)
def _gelu(x):
    return torch.nn.functional.gelu(x, approximate="tanh")
def _silu(x):
    return torch.nn.functional.silu(x)
def _sigmoid(x):
    return torch.sigmoid(x)
def _layernorm(x, axis=-1, eps=1e-5):
    m = x.mean(dim=axis, keepdim=True)
    v = x.var(dim=axis, keepdim=True, unbiased=False)
    return (x - m) / torch.sqrt(v + eps)
def _scatter_add(tgt, idx, src, axis=0):
    return tgt.clone().index_add_(axis, idx, src)
def _segment_sum(src, seg, n):
    out = torch.zeros((n,) + src.shape[1:], dtype=src.dtype)
    return out.index_add_(0, seg, src)
def _pad(x, pw):
    flat = tuple(v for pair in reversed(pw) for v in pair)
    return torch.nn.functional.pad(x, flat)

kernel_name = 'gated_mix__linear_kernel_hedgehog__dense_activation_silu__prompt'

def setup_inputs():

    _w = (lambda a: (lambda t: t.to(torch.bfloat16) if t.is_floating_point() else t)(torch.as_tensor(a)))
    def _A_setup():
        B, S, D, H = 1, 2048, 640, 32
        Dh = D // H
        return {
            "x": _w((lambda *s: torch.randn(*s, dtype=torch.bfloat16) * 0.1)(B, S, D)),
            "wqkv": _w((lambda *s: torch.randn(*s, dtype=torch.bfloat16) * 0.8)(D, 3 * D)),
            "w_phi": _w((lambda *s: torch.randn(*s, dtype=torch.bfloat16) * 0.8)(H, Dh, Dh) * (Dh ** -0.5)),
            "wo": _w((lambda *s: torch.randn(*s, dtype=torch.bfloat16) * 0.2)(D, D)),
        }
    _A_in = _A_setup()

    def _B_setup():
        B, S, D, F = 1, 2048, 640, 1728
        return {
            "x": _w((lambda *s: torch.randn(*s, dtype=torch.bfloat16) * 0.1)(B, S, D)),
            "w1": _w((lambda *s: torch.randn(*s, dtype=torch.bfloat16) * 3.2)(D, F) * (D ** -0.5)),
            "w2": _w((lambda *s: torch.randn(*s, dtype=torch.bfloat16) * 3.2)(F, D) * (F ** -0.5)),
        }
    _B_in = _B_setup()

    return {
        "A_x": _A_in["x"],
        "A_wqkv": _A_in["wqkv"],
        "A_w_phi": _A_in["w_phi"],
        "A_wo": _A_in["wo"],
        "B_x": _B_in["x"],
        "B_w1": _B_in["w1"],
        "B_w2": _B_in["w2"],
        "gate_w": _w((lambda *s: torch.randn(*s, dtype=torch.bfloat16) * 0.1)(640) * 16.0),
    }

def reference(A_x, A_wqkv, A_w_phi, A_wo, B_x, B_w1, B_w2, gate_w):
    def _A_ref(x, wqkv, w_phi, wo):
        B, S, D = x.shape
        H = 32; Dh = D // H
        qkv = (lambda x, *d: x.permute(*d))((x @ wqkv).reshape(B, S, 3, H, Dh), 2, 0, 3, 1, 4)
        q, k, v = qkv[0], qkv[1], qkv[2]
        pq = torch.einsum("bhsd,hdf->bhsf", q, w_phi)
        pk = torch.einsum("bhsd,hdf->bhsf", k, w_phi)
        phi_q = torch.concatenate([_softmax(pq, axis=-1), _softmax(-pq, axis=-1)], axis=-1)
        phi_k = torch.concatenate([_softmax(pk, axis=-1), _softmax(-pk, axis=-1)], axis=-1)
        kv = torch.einsum("bhsf,bhsd->bhfd", phi_k, v)
        z  = torch.einsum("bhsf->bhf", phi_k)
        num = torch.einsum("bhqf,bhfd->bhqd", phi_q, kv)
        den = torch.einsum("bhqf,bhf->bhq", phi_q, z)[..., None] + 1e-6
        o = num / den
        return (lambda x, *d: x.permute(*d))(o, 0, 2, 1, 3).reshape(B, S, D) @ wo

    def _B_ref(x, w1, w2):
        h = torch.einsum("bsd,df->bsf", x, w1)
        h = _silu(h)
        out = torch.einsum("bsf,fd->bsd", h, w2)
        return out

    x = A_x
    g = _sigmoid((x * gate_w).sum(-1, keepdims=True))
    a = _A_ref(x, A_wqkv, A_w_phi, A_wo)
    b = _B_ref(x, B_w1, B_w2)
    return g * a + (1 - g) * b
```

```asm
; @launch grid=(256,1,1) block=(512,1,1) lds=163840
.amdgcn_target "amdgcn-amd-amdhsa--gfx950"
.text
.globl gated_mix__linear_kernel_hedgehog__dense_activation_silu__prompt_kernel
.p2align 8
.type gated_mix__linear_kernel_hedgehog__dense_activation_silu__prompt_kernel,@function
gated_mix__linear_kernel_hedgehog__dense_activation_silu__prompt_kernel:
    s_cmp_ge_u32 s2, 256
    s_cbranch_scc1 L_END
    s_load_dwordx16 s[40:55], s[0:1], 0
    s_load_dwordx4 s[56:59], s[0:1], 64
    s_load_dwordx2 s[60:61], s[0:1], 80
    v_lshrrev_b32 v3, 6, v0
    v_and_b32 v1, 63, v0
    v_readfirstlane_b32 s62, v3
    v_lshlrev_b32 v2, 4, v1
    s_and_b32 s79, s2, 7
    s_bfe_u32 s77, s2, 0x30003
    s_lshr_b32 s35, s2, 6
    s_and_b32 s63, s79, 1
    s_lshl_b32 s63, s63, 3
    s_add_u32 s63, s63, s77
    s_and_b32 s78, s79, 6
    s_lshl_b32 s64, s78, 1
    s_add_u32 s64, s64, s35
    s_lshl_b32 s69, s62, 11
    s_mov_b32 s101, 1073741824
    s_add_u32 s79, s63, s64
    s_mul_i32 s76, s35, 3
    s_add_u32 s76, s76, 1
    s_lshr_b32 s76, s76, 1
    s_add_u32 s79, s79, s76
    s_mul_i32 s76, s79, 26
    s_lshr_b32 s76, s76, 8
    s_mul_i32 s76, s76, 10
    s_sub_u32 s70, s79, s76
    s_lshl_b32 s79, s63, 3
    s_add_u32 s79, s79, s62
    s_mul_i32 s79, s79, 20480
    s_lshl_b32 s76, s70, 7
    s_add_u32 s71, s79, s76
    v_lshrrev_b32 v3, 3, v1
    v_mul_u32_u24 v3, 1280, v3
    v_and_b32 v4, 7, v1
    v_lshrrev_b32 v176, 4, v1
    v_xor_b32 v4, v4, v176
    v_lshl_add_u32 v64, v4, 4, v3
    v_xor_b32 v65, 64, v64
    v_add_u32 v65, 9216, v65
    s_lshl_b32 s79, s64, 8
    s_lshl_b32 s76, s64, 7
    s_add_u32 s76, s76, 1408
    s_min_u32 s79, s79, s76
    s_lshl_b32 s75, s79, 4
    s_lshl_b32 s76, s70, 3
    s_add_u32 s76, s76, s62
    s_mul_i32 s76, s76, 27648
    s_add_u32 s72, s79, s76
    v_and_b32 v175, 3, v1
    v_bfe_u32 v174, v1, 2, 2
    v_mul_u32_u24 v3, 3456, v174
    v_lshl_add_u32 v3, v176, 6, v3
    v_lshl_add_u32 v3, v175, 4, v3
    s_cmp_ge_u32 s64, 11
    s_cselect_b32 vcc_hi, 0, -1
    s_mov_b32 vcc_lo, -1
    v_cndmask_b32_e64 v66, 2.0, v3, vcc
    v_add_u32 v67, 12800, v66
    s_mov_b32 s74, s70
    s_mov_b32 s34, s70
    s_mov_b32 s6, 2621440
    s_mov_b32 s7, 0x00020000
    s_mov_b32 s10, 2211840
    s_mov_b32 s11, 0x00020000
    s_mul_i32 s79, s63, 5
    s_add_u32 s79, s79, s62
    s_sub_u32 s79, s79, 3
    s_mul_i32 s96, s79, 30720
    s_mul_i32 s97, s64, 80
    s_add_u32 s96, s96, s97
    s_add_u32 s97, s96, 14400
    v_mul_u32_u24 v166, 4370, v1
    v_lshrrev_b32 v166, 16, v166
    v_mul_u32_u24 v167, 15, v166
    v_sub_u32 v167, v1, v167
    v_mul_u32_u24 v168, 52, v167
    v_lshrrev_b32 v168, 8, v168
    v_mul_u32_u24 v166, 3840, v166
    v_lshl_add_u32 v166, v167, 4, v166
    v_mul_u32_u24 v168, 1200, v168
    v_add_u32 v192, v166, v168
    s_cmp_ge_u32 s63, 6
    s_cselect_b32 s20, 1, 0
    s_lshl_b32 s76, s64, 1
    s_add_u32 s76, s76, s20
    s_mul_i32 s76, s76, 800
    s_cmp_eq_u32 s62, 3
    s_cselect_b32 s76, s76, 1073741824
    v_cmp_gt_u32 vcc, 50, v1
    s_lshl_b32 s22, s79, 4
    s_nop 0
    v_cndmask_b32_e64 v193, 2.0, v2, vcc
    s_waitcnt lgkmcnt(0)
    s_mov_b64 s[4:5], s[40:41]
    s_mov_b64 s[8:9], s[50:51]
    s_add_u32 m0, s69, 0
    s_nop 0
    buffer_load_dwordx4 v64, s[4:7], s71 offen lds
    s_add_u32 m0, s69, 0
    s_nop 0
    buffer_load_dwordx4 v65, s[4:7], s71 offen offset:1024 lds
    s_add_u32 s70, s70, 1
    s_cmp_eq_u32 s70, 10
    s_mov_b32 s98, 128
    s_cmov_b32 s98, -1152
    s_cselect_b32 s70, 0, s70
    s_add_u32 s71, s71, s98
    s_add_u32 m0, s69, 16384
    s_nop 0
    buffer_load_dwordx4 v66, s[8:11], s72 offen lds
    s_add_u32 m0, s69, 16384
    s_nop 0
    buffer_load_dwordx4 v67, s[8:11], s72 offen offset:1024 lds
    s_add_u32 s34, s34, 1
    s_cmp_eq_u32 s34, 10
    s_mov_b32 s98, 221184
    s_cmov_b32 s98, -1990656
    s_cselect_b32 s34, 0, s34
    s_add_u32 s72, s72, s98
    s_and_b32 s67, s62, 3
    s_lshr_b32 s68, s62, 2
    s_mov_b32 s12, s60
    s_mov_b32 s13, s61
    s_mov_b32 s14, 268435456
    s_mov_b32 s15, 0x00020000
    buffer_load_dword v194, off, s[12:15], 0 offset:0 sc1
    s_mov_b32 s16, s42
    s_mov_b32 s17, s43
    s_mov_b32 s18, 2457600
    s_mov_b32 s19, 0x00020000
    s_mov_b32 s36, s44
    s_mov_b32 s37, s45
    s_mov_b32 s38, 25600
    s_mov_b32 s39, 0x00020000
    s_mov_b64 s[0:1], s[54:55]
    s_mov_b64 s[60:61], s[46:47]
    s_mov_b32 s24, s52
    s_mov_b32 s25, s53
    s_mov_b32 s26, 2211840
    s_mov_b32 s27, 0x00020000
    s_and_b32 s66, s2, 4
    s_add_u32 s66, s66, s35
    s_bfe_u32 s65, s2, 0x10001
    s_lshl4_add_u32 s65, s65, s63
    v_mov_b32 v236, -1
    v_mov_b32 v237, -1
    v_mov_b32 v238, -1
    v_mov_b32 v239, -1
    v_lshlrev_b32 v172, 4, v0
    v_cmp_gt_u32 vcc, 416, v0
    v_and_b32 v166, 31, v1
    v_lshlrev_b32 v166, 4, v166
    v_lshrrev_b32 v167, 5, v1
    v_lshl_add_u32 v166, v167, 10, v166
    v_cndmask_b32_e64 v167, 2.0, v172, vcc
    s_cmp_ge_u32 s62, 3
    s_cbranch_scc1 L_ROLEA2
    s_mov_b32 s52, s101
    s_mov_b32 s53, s101
    s_mov_b32 s54, s101
    v_mov_b32 v173, 0
    v_mov_b32 v169, 0
    v_mov_b32 v170, 0
    s_branch L_JOIN0
L_ROLEA2:
    v_lshl_add_u32 v168, v176, 2, v175
    v_and_b32 v169, 7, v168
    v_lshrrev_b32 v170, 3, v168
    v_lshlrev_b32 v171, 4, v169
    v_lshl_add_u32 v171, v170, 3, v171
    v_add_u32 v171, 80, v171
    v_mul_u32_u24 v172, 80, v170
    v_lshlrev_b32 v173, 3, v169
    v_sub_u32 v173, v173, v172
    v_add_u32 v173, 80, v173
    v_cmp_le_u32 vcc, 5, v169
    s_nop 1
    v_cndmask_b32_e32 v173, v173, v171, vcc
    v_mul_u32_u24 v171, 240, v174
    v_add_u32 v173, v173, v171
    v_add_u32 v173, s69, v173
    v_add_u32 v173, 124928, v173
    s_mul_i32 s45, s20, 6
    s_sub_u32 s45, s63, s45
    s_cmp_ge_u32 s45, 3
    s_cselect_b32 s48, 0x3333, -1
    s_cselect_b32 s53, 0, 8
    s_cselect_b32 s46, 32, 0
    s_cmp_ge_u32 s45, 4
    s_cselect_b32 s50, 0xcccc, s48
    s_cmp_eq_u32 s45, 4
    s_cmov_b32 s48, 0xcccc
    s_cmp_eq_u32 s45, 2
    s_cmov_b32 s48, 0
    s_cmp_eq_u32 s45, 1
    s_cmov_b32 s50, 0
    s_bitcmp1_b32 0x26, s45
    s_cselect_b32 s49, 0, s48
    s_cselect_b32 s51, 0, s50
    s_cselect_b32 s45, 640, 0
    s_mov_b32 s47, 320
    s_cmov_b32 s47, 640
    s_add_u32 s45, s45, s46
    s_add_u32 s47, s47, s46
    v_bfe_u32 v168, v1, 4, 1
    v_bfe_u32 v169, v1, 1, 1
    v_lshl_add_u32 v168, v168, 1, v169
    v_mul_u32_u24 v168, s53, v168
    v_lshrrev_b32 v169, 5, v1
    v_lshl_add_u32 v169, v169, 2, v174
    v_mul_u32_u24 v169, 40, v169
    v_add_u32 v168, v168, v169
    v_add_u32 v169, s45, v168
    v_add_u32 v170, s47, v168
    v_mov_b32 v168, 800
    v_cndmask_b32_e64 v169, v168, v169, s[48:49]
    v_cndmask_b32_e64 v170, v168, v170, s[50:51]
    v_add_u32 v169, 141312, v169
    v_add_u32 v170, 141312, v170
    v_bfe_i32 v168, v1, 2, 1
    v_and_b32 v168, 0x80008000, v168
    s_mul_i32 s52, s64, 163840
    s_lshr_b32 s53, s79, 1
    s_lshl_b32 s53, s53, 12
    s_add_u32 s52, s52, s53
    s_and_b32 s53, s79, 1
    s_lshl_b32 s53, s53, 9
    s_add_u32 s52, s52, s53
    s_add_u32 s52, s52, 4096
    s_mul_i32 s53, s64, 12
    s_add_u32 s53, s53, s63
    s_lshl_b32 s53, s53, 10
    s_add_u32 s53, s53, 2686976
    s_cmp_eq_u32 s62, 3
    s_cselect_b32 s53, s53, 1073741824
    s_cmp_lt_u32 s63, 12
    s_cselect_b32 s53, s53, 1073741824
    s_lshl4_add_u32 s54, s64, s63
    s_mul_i32 s54, s54, 3584
    s_add_u32 s54, s54, 16774144
    s_cmp_eq_u32 s62, 7
    s_cselect_b32 s54, s101, s54
L_JOIN0:
    v_cmp_eq_u32 s[48:49], 60, v1
    v_cmp_le_u32 s[50:51], 60, v1
    s_mul_i32 s40, s64, 163840
    s_lshl_b32 s41, s74, 14
    s_add_u32 s40, s40, s41
    s_add_u32 s73, s40, s69
    s_add_u32 s73, s73, 4096
    v_and_b32 v84, 31, v1
    s_lshl_b32 s40, s67, 12
    v_lshlrev_b32 v85, 7, v84
    v_add_u32 v85, s40, v85
    v_bfe_u32 v86, v1, 1, 3
    v_lshrrev_b32 v87, 5, v1
    v_xor_b32 v86, v86, v87
    v_lshl_add_u32 v68, v86, 4, v85
    v_xor_b32 v69, 32, v68
    v_xor_b32 v70, 64, v68
    v_xor_b32 v71, 96, v68
    v_lshlrev_b32 v84, 11, v87
    v_bfe_u32 v85, v1, 2, 2
    v_lshl_add_u32 v84, v85, 6, v84
    v_bfe_u32 v85, v1, 4, 1
    v_lshl_add_u32 v84, v85, 5, v84
    v_and_b32 v85, 1, v1
    v_lshl_add_u32 v84, v85, 4, v84
    v_bfe_u32 v85, v1, 1, 1
    v_lshl_add_u32 v84, v85, 3, v84
    s_lshl_b32 s40, s68, 9
    v_add_u32 v80, s40, v84
    v_add_u32 v72, 65536, v68
    v_add_u32 v73, 65536, v69
    v_add_u32 v74, 65536, v70
    v_add_u32 v75, 65536, v71
    v_add_u32 v81, 65536, v80
    v_add_u32 v76, 131072, v68
    v_add_u32 v77, 131072, v69
    v_add_u32 v78, 131072, v70
    v_add_u32 v79, 131072, v71
    v_add_u32 v82, 131072, v80
    s_lshl_b32 s40, s68, 11
    v_add_u32 v3, s40, v2
    s_mov_b32 s32, 0xbfb8aa3b
    s_mov_b32 s33, 0xbfb8aa3b
    v_add_u32 v4, 65536, v3
    v_add_u32 v5, 131072, v3
    s_lshl2_add_u32 s40, s63, s67
    s_mul_i32 s29, s40, 151552
    s_add_u32 s29, s29, 6291456
    v_bfe_u32 v83, v1, 4, 1
    v_mul_u32_u24 v83, 75776, v83
    v_lshrrev_b32 v84, 5, v1
    v_lshl_add_u32 v83, v84, 8, v83
    v_and_b32 v84, 15, v1
    v_lshl_add_u32 v83, v84, 4, v83
    s_add_u32 s75, s75, s29
    s_lshl_b32 s41, s68, 11
    s_add_u32 s75, s75, s41
    s_cmp_ge_u32 s64, 11
    s_cselect_b32 s41, s68, 0
    s_cmp_eq_u32 s41, 0
    s_cselect_b32 s75, s75, s101
    s_mul_i32 s41, s64, 1280
    s_add_u32 s29, s29, s41
    s_add_u32 s29, s29, 55296
    s_lshl_b32 s23, s40, 7
    s_add_u32 s23, s23, 17825792
    s_xor_b32 s41, s68, 1
    s_or_b32 s41, s64, s41
    s_cmp_eq_u32 s41, 0
    s_cselect_b32 s23, s23, s101
    s_mul_i32 s41, s66, 160
    s_mul_i32 s28, s65, 40960
    s_mul_i32 s40, s62, 5120
    s_add_u32 s28, s28, s40
    s_add_u32 s28, s28, s41
    s_add_u32 s40, s65, 10
    s_sub_u32 s58, s65, 22
    s_cmp_lt_u32 s65, 10
    s_cselect_b32 s40, s40, s58
    s_add_u32 s78, s40, 54
    s_cmp_lt_u32 s40, 20
    s_cselect_b32 s78, s78, 255
    s_cselect_b32 s40, s40, 0
    s_lshl_b32 s40, s40, 2
    s_lshr_b32 s58, s62, 1
    s_add_u32 s40, s40, s58
    s_mul_i32 s58, s40, 205
    s_lshr_b32 s58, s58, 10
    s_mul_i32 s58, s58, 5
    s_sub_u32 s58, s40, s58
    s_lshl_b32 s40, s40, 3
    s_and_b32 s59, s62, 1
    s_lshl_b32 s3, s59, 2
    s_cmp_ge_u32 s58, 2
    s_cselect_b32 s42, 4, 0
    s_add_u32 s3, s3, s42
    s_cmp_eq_u32 s59, 0
    s_cselect_b32 s59, -16, 4
    s_cmp_eq_u32 s58, 4
    s_cselect_b32 s3, s59, s3
    s_add_u32 s3, s3, s40
    s_mul_i32 s3, s3, 1280
    s_add_u32 s3, s3, s41
    s_cmp_lt_u32 s78, 74
    s_cselect_b32 s3, s3, s101
    s_add_u32 s40, s65, 32
    s_cmp_lt_u32 s65, 22
    s_cselect_b32 s40, s40, 255
    s_cmp_ge_u32 s62, 2
    s_cselect_b32 s78, s78, s40
    s_mov_b32 s59, 5216
    s_cmov_b32 s59, 10176
    s_cselect_b32 s41, -2, 3
    s_cmp_eq_u32 s62, 7
    s_cselect_b32 s78, 255, s78
    s_cmp_ge_u32 s62, 5
    s_cselect_b32 s77, s40, s65
    s_cselect_b32 s58, 4960, 0
    s_cselect_b32 s40, -5, 0
    s_lshl_b32 s42, s62, 5
    s_add_u32 s42, s42, 16384
    s_add_u32 s58, s58, s42
    s_add_u32 s59, s59, s42
    s_mul_i32 s42, s66, 74
    s_add_u32 s40, s40, s62
    s_lshl_b32 s40, s40, 10
    s_add_u32 s43, s42, s77
    s_mul_i32 s43, s43, 5120
    s_add_u32 s43, s43, s40
    s_add_u32 s43, s43, 3145728
    s_cmp_lt_u32 s77, 74
    s_cselect_b32 s77, s43, s101
    s_add_u32 s41, s41, s62
    s_lshl_b32 s41, s41, 10
    s_add_u32 s43, s42, s78
    s_mul_i32 s43, s43, 5120
    s_add_u32 s43, s43, s41
    s_add_u32 s43, s43, 3145728
    s_cmp_lt_u32 s78, 74
    s_cselect_b32 s78, s43, s101
    v_mul_u32_u24 v95, 6554, v1
    v_lshrrev_b32 v95, 16, v95
    v_mul_u32_u24 v95, 1120, v95
    v_add_u32 v95, v95, v2
    s_add_u32 m0, s69, 124928
    s_cmp_lt_u32 s62, 3
    s_cselect_b32 s96, s101, s96
    s_cselect_b32 s97, s101, s97
    s_cselect_b32 s22, s101, s22
    s_cselect_b32 exec_lo, 0, -1
    s_cselect_b32 exec_hi, 0, 0x0fffffff
    buffer_load_dwordx4 v192, s[16:19], s96 offen lds
    buffer_load_dwordx4 v192, s[16:19], s97 offen offset:960 lds
    s_mov_b32 m0, 141312
    s_cmp_eq_u32 s76, s101
    s_cselect_b64 exec, 0, -1
    buffer_load_dwordx4 v193, s[36:39], s76 offen lds
    s_mov_b64 exec, -1
    s_mov_b64 s[36:37], s[0:1]
    s_mov_b32 s38, 1280
    s_cmp_eq_u32 s22, s101
    s_cselect_b64 exec, 0, -1
    buffer_load_dwordx4 v[240:243], off, s[36:39], s22
    s_mov_b64 exec, -1
    s_add_u32 m0, s69, 32768
    s_nop 0
    buffer_load_dwordx4 v64, s[4:7], s71 offen lds
    s_add_u32 m0, s69, 32768
    s_nop 0
    buffer_load_dwordx4 v65, s[4:7], s71 offen offset:1024 lds
    s_add_u32 s70, s70, 1
    s_cmp_eq_u32 s70, 10
    s_mov_b32 s98, 128
    s_cmov_b32 s98, -1152
    s_cselect_b32 s70, 0, s70
    s_add_u32 s71, s71, s98
    s_add_u32 m0, s69, 65536
    s_nop 0
    buffer_load_dwordx4 v64, s[4:7], s71 offen lds
    s_add_u32 m0, s69, 65536
    s_nop 0
    buffer_load_dwordx4 v65, s[4:7], s71 offen offset:1024 lds
    s_add_u32 s70, s70, 1
    s_cmp_eq_u32 s70, 10
    s_mov_b32 s98, 128
    s_cmov_b32 s98, -1152
    s_cselect_b32 s70, 0, s70
    s_add_u32 s71, s71, s98
    s_waitcnt vmcnt(9)
    s_barrier
    ds_read_b128 v[96:99], v68 offset:0
    ds_read_b64_tr_b16 v[8:9], v80 offset:16384
    ds_read_b64_tr_b16 v[10:11], v80 offset:17408
    ds_read_b64_tr_b16 v[12:13], v80 offset:16640
    ds_read_b64_tr_b16 v[14:15], v80 offset:17664
    s_add_u32 m0, s69, 49152
    s_nop 0
    buffer_load_dwordx4 v66, s[8:11], s72 offen lds
    s_add_u32 m0, s69, 49152
    s_nop 0
    buffer_load_dwordx4 v67, s[8:11], s72 offen offset:1024 lds
    s_add_u32 s34, s34, 1
    s_cmp_eq_u32 s34, 10
    s_mov_b32 s98, 221184
    s_cmov_b32 s98, -1990656
    s_cselect_b32 s34, 0, s34
    s_add_u32 s72, s72, s98
    s_add_u32 m0, s69, 81920
    s_nop 0
    buffer_load_dwordx4 v66, s[8:11], s72 offen lds
    s_add_u32 m0, s69, 81920
    s_nop 0
    buffer_load_dwordx4 v67, s[8:11], s72 offen offset:1024 lds
    s_add_u32 s34, s34, 1
    s_cmp_eq_u32 s34, 10
    s_mov_b32 s98, 221184
    s_cmov_b32 s98, -1990656
    s_cselect_b32 s34, 0, s34
    s_add_u32 s72, s72, s98
    ds_read_b128 v[100:103], v69 offset:0
    ds_read_b64_tr_b16 v[16:17], v80 offset:20480
    ds_read_b64_tr_b16 v[18:19], v80 offset:21504
    ds_read_b64_tr_b16 v[20:21], v80 offset:20736
    ds_read_b64_tr_b16 v[22:23], v80 offset:21760
    ds_read_b128 v[104:107], v70 offset:0
    ds_read_b64_tr_b16 v[24:25], v80 offset:24576
    ds_read_b64_tr_b16 v[26:27], v80 offset:25600
    ds_read_b64_tr_b16 v[28:29], v80 offset:24832
    ds_read_b64_tr_b16 v[30:31], v80 offset:25856
    s_waitcnt lgkmcnt(12)
    v_mfma_f32_32x32x16_bf16 v[32:47], v[8:11], v[96:99], 0
    s_add_u32 m0, s69, 98304
    s_nop 0
    buffer_load_dwordx4 v64, s[4:7], s71 offen lds
    s_waitcnt lgkmcnt(10)
    v_mfma_f32_32x32x16_bf16 v[48:63], v[12:15], v[96:99], 0
    s_add_u32 m0, s69, 98304
    s_nop 0
    buffer_load_dwordx4 v65, s[4:7], s71 offen offset:1024 lds
    s_add_u32 s70, s70, 1
    s_cmp_eq_u32 s70, 10
    s_mov_b32 s98, 128
    s_cmov_b32 s98, -1152
    s_cselect_b32 s70, 0, s70
    s_add_u32 s71, s71, s98
    ds_read_b128 v[108:111], v71 offset:0
    ds_read_b64_tr_b16 v[8:9], v80 offset:28672
    ds_read_b64_tr_b16 v[10:11], v80 offset:29696
    ds_read_b64_tr_b16 v[12:13], v80 offset:28928
    ds_read_b64_tr_b16 v[14:15], v80 offset:29952
    s_waitcnt lgkmcnt(12)
    v_mfma_f32_32x32x16_bf16 v[32:47], v[16:19], v[100:103], v[32:47]
    s_add_u32 m0, s69, 114688
    s_nop 0
    buffer_load_dwordx4 v66, s[8:11], s72 offen lds
    s_waitcnt lgkmcnt(10)
    v_mfma_f32_32x32x16_bf16 v[48:63], v[20:23], v[100:103], v[48:63]
    s_add_u32 m0, s69, 114688
    s_nop 0
    buffer_load_dwordx4 v67, s[8:11], s72 offen offset:1024 lds
    s_add_u32 s34, s34, 1
    s_cmp_eq_u32 s34, 10
    s_mov_b32 s98, 221184
    s_cmov_b32 s98, -1990656
    s_cselect_b32 s34, 0, s34
    s_add_u32 s72, s72, s98
    s_waitcnt lgkmcnt(0)
    v_mfma_f32_32x32x16_bf16 v[32:47], v[24:27], v[104:107], v[32:47]
    v_mfma_f32_32x32x16_bf16 v[48:63], v[28:31], v[104:107], v[48:63]
    s_waitcnt vmcnt(16)
    v_readfirstlane_b32 s100, v194
    s_waitcnt vmcnt(6)
    s_barrier
    s_add_u32 s100, s100, 1
    ds_read_b128 v[112:115], v68 offset:32768
    ds_read_b64_tr_b16 v[16:17], v80 offset:49152
    ds_read_b64_tr_b16 v[18:19], v80 offset:50176
    ds_read_b64_tr_b16 v[20:21], v80 offset:49408
    ds_read_b64_tr_b16 v[22:23], v80 offset:50432
    s_add_u32 m0, s69, 147456
    s_nop 0
    buffer_load_dwordx4 v66, s[8:11], s72 offen lds
    v_mfma_f32_32x32x16_bf16 v[32:47], v[8:11], v[108:111], v[32:47]
    v_mfma_f32_32x32x16_bf16 v[48:63], v[12:15], v[108:111], v[48:63]
    s_add_u32 m0, s69, 147456
    s_nop 0
    buffer_load_dwordx4 v67, s[8:11], s72 offen offset:1024 lds
    s_add_u32 s34, s34, 1
    s_cmp_eq_u32 s34, 10
    s_mov_b32 s98, 221184
    s_cmov_b32 s98, -1990656
    s_cselect_b32 s34, 0, s34
    s_add_u32 s72, s72, s98
    ds_read_b128 v[116:119], v69 offset:32768
    ds_read_b64_tr_b16 v[24:25], v80 offset:53248
    ds_read_b64_tr_b16 v[26:27], v80 offset:54272
    ds_read_b64_tr_b16 v[28:29], v80 offset:53504
    ds_read_b64_tr_b16 v[30:31], v80 offset:54528
    ds_read_b128 v[120:123], v70 offset:32768
    ds_read_b64_tr_b16 v[8:9], v80 offset:57344
    ds_read_b64_tr_b16 v[10:11], v80 offset:58368
    ds_read_b64_tr_b16 v[12:13], v80 offset:57600
    ds_read_b64_tr_b16 v[14:15], v80 offset:58624
    s_waitcnt lgkmcnt(12)
    v_mfma_f32_32x32x16_bf16 v[32:47], v[16:19], v[112:115], v[32:47]
    s_waitcnt lgkmcnt(10)
    v_mfma_f32_32x32x16_bf16 v[48:63], v[20:23], v[112:115], v[48:63]
    s_add_u32 m0, s69, 16384
    s_nop 0
    buffer_load_dwordx4 v66, s[8:11], s72 offen lds
    ds_read_b128 v[124:127], v71 offset:32768
    ds_read_b64_tr_b16 v[16:17], v80 offset:61440
    ds_read_b64_tr_b16 v[18:19], v80 offset:62464
    ds_read_b64_tr_b16 v[20:21], v80 offset:61696
    ds_read_b64_tr_b16 v[22:23], v80 offset:62720
    ds_read_b64_tr_b16 v[224:225], v173 offset:0
    ds_read_b64_tr_b16 v[226:227], v173 offset:960
    ds_read_b64_tr_b16 v[228:229], v173 offset:40
    ds_read_b64_tr_b16 v[230:231], v173 offset:1000
    ds_read_b64_tr_b16 v[232:233], v169
    ds_read_b64_tr_b16 v[234:235], v170
    s_waitcnt lgkmcnt(15)
    v_mfma_f32_32x32x16_bf16 v[32:47], v[24:27], v[116:119], v[32:47]
    s_cmp_eq_u32 s54, s101
    s_cselect_b64 exec, 0, -1
    buffer_store_dwordx4 v[236:239], v167, s[12:15], s54 offen sc1
    s_mov_b64 exec, -1
    v_cndmask_b32_e64 v240, 0, v240, s[48:49]
    v_cndmask_b32_e64 v241, 0, v241, s[48:49]
    v_cndmask_b32_e64 v242, 0, v242, s[48:49]
    v_mfma_f32_32x32x16_bf16 v[48:63], v[28:31], v[116:119], v[48:63]
    s_add_u32 m0, s69, 16384
    s_nop 0
    buffer_load_dwordx4 v67, s[8:11], s72 offen offset:1024 lds
    s_add_u32 s34, s34, 1
    s_cmp_eq_u32 s34, 10
    s_mov_b32 s98, 221184
    s_cmov_b32 s98, -1990656
    s_cselect_b32 s34, 0, s34
    s_add_u32 s72, s72, s98
    v_cndmask_b32_e64 v243, 0, v243, s[48:49]
    s_waitcnt lgkmcnt(5)
    v_cndmask_b32_e64 v224, v224, v240, s[50:51]
    v_cndmask_b32_e64 v225, v225, v241, s[50:51]
    s_waitcnt lgkmcnt(4)
    v_cndmask_b32_e64 v226, v226, v242, s[50:51]
    v_cndmask_b32_e64 v227, v227, v243, s[50:51]
    s_waitcnt lgkmcnt(0)
    v_mfma_f32_32x32x16_bf16 v[32:47], v[8:11], v[120:123], v[32:47]
    s_cmp_eq_u32 s52, s101
    s_cselect_b64 exec, 0, -1
    buffer_store_dwordx4 v[224:227], v166, s[12:15], s52 offen sc1
    s_mov_b64 exec, -1
    v_cndmask_b32_e64 v228, v228, v240, s[50:51]
    v_cndmask_b32_e64 v229, v229, v241, s[50:51]
    v_cndmask_b32_e64 v230, v230, v242, s[50:51]
    v_mfma_f32_32x32x16_bf16 v[48:63], v[12:15], v[120:123], v[48:63]
    v_cndmask_b32_e64 v231, v231, v243, s[50:51]
    s_cmp_eq_u32 s52, s101
    s_cselect_b64 exec, 0, -1
    buffer_store_dwordx4 v[228:231], v166, s[12:15], s52 offen offset:2048 sc1
    s_mov_b64 exec, -1
    v_xor_b32 v232, v232, v168
    v_xor_b32 v233, v233, v168
    s_waitcnt vmcnt(11)
    s_barrier
    ds_read_b128 v[128:131], v72 offset:0
    ds_read_b64_tr_b16 v[24:25], v81 offset:16384
    ds_read_b64_tr_b16 v[26:27], v81 offset:17408
    ds_read_b64_tr_b16 v[28:29], v81 offset:16640
    ds_read_b64_tr_b16 v[30:31], v81 offset:17664
    s_add_u32 m0, s69, 131072
    s_nop 0
    buffer_load_dwordx4 v64, s[4:7], s71 offen lds
    s_add_u32 m0, s69, 131072
    s_nop 0
    buffer_load_dwordx4 v65, s[4:7], s71 offen offset:1024 lds
    s_add_u32 s70, s70, 1
    s_cmp_eq_u32 s70, 10
    s_mov_b32 s98, 128
    s_cmov_b32 s98, -1152
    s_cselect_b32 s70, 0, s70
    s_add_u32 s71, s71, s98
    v_mfma_f32_32x32x16_bf16 v[32:47], v[16:19], v[124:127], v[32:47]
    s_add_u32 m0, s69, 0
    s_nop 0
    buffer_load_dwordx4 v64, s[4:7], s71 offen lds
    v_xor_b32 v234, v234, v168
    v_xor_b32 v235, v235, v168
    s_cmp_eq_u32 s53, s101
    s_cselect_b64 exec, 0, -1
    buffer_store_dwordx4 v[232:235], v2, s[12:15], s53 offen sc1
    s_mov_b64 exec, -1
    v_mfma_f32_32x32x16_bf16 v[48:63], v[20:23], v[124:127], v[48:63]
    s_add_u32 m0, s69, 0
    s_nop 0
    buffer_load_dwordx4 v65, s[4:7], s71 offen offset:1024 lds
    s_add_u32 s70, s70, 1
    s_cmp_eq_u32 s70, 10
    s_mov_b32 s98, 128
    s_cmov_b32 s98, -1152
    s_cselect_b32 s70, 0, s70
    s_add_u32 s71, s71, s98
    ds_read_b128 v[132:135], v73 offset:0
    ds_read_b64_tr_b16 v[8:9], v81 offset:20480
    ds_read_b64_tr_b16 v[10:11], v81 offset:21504
    ds_read_b64_tr_b16 v[12:13], v81 offset:20736
    ds_read_b64_tr_b16 v[14:15], v81 offset:21760
    ds_read_b128 v[136:139], v74 offset:0
    ds_read_b64_tr_b16 v[16:17], v81 offset:24576
    ds_read_b64_tr_b16 v[18:19], v81 offset:25600
    ds_read_b64_tr_b16 v[20:21], v81 offset:24832
    ds_read_b64_tr_b16 v[22:23], v81 offset:25856
    s_waitcnt lgkmcnt(12)
    v_mfma_f32_32x32x16_bf16 v[32:47], v[24:27], v[128:131], v[32:47]
    s_add_u32 m0, s69, 32768
    s_nop 0
    buffer_load_dwordx4 v64, s[4:7], s71 offen lds
    s_bfe_u32 s42, s2, 0x10002
    s_and_b32 s43, s63, 11
    s_and_b32 s40, s2, 2
    s_lshl1_add_u32 s43, s40, s43
    s_lshr_b32 s44, s2, 5
    s_mul_i32 s40, s42, 27
    s_mul_i32 s98, s44, 378880
    s_add_u32 s19, s98, 3422208
    s_add_u32 s98, s98, s69
    s_mul_i32 s99, s40, 5120
    s_add_u32 s98, s98, s99
    s_add_u32 s18, s98, 3145728
    s_bfe_u32 s79, s62, 0x10001
    s_xor_b32 s99, s42, s68
    s_xor_b32 s99, s99, 1
    s_lshl1_add_u32 s98, s43, s99
    s_and_b32 s99, s62, 1
    s_lshl1_add_u32 s98, s98, s99
    s_mul_i32 s41, s98, 151552
    s_sub_u32 s98, s40, s79
    s_lshl_b32 s98, s98, 10
    s_add_u32 s98, s98, s41
    s_add_u32 s96, s98, 6292480
    s_mul_i32 s98, s79, 75776
    s_add_u32 s16, s96, s98
    s_sub_u32 s17, s96, s98
    s_add_u32 s17, s17, 75776
    s_cmp_eq_u32 s79, 0
    s_mov_b32 s0, 6350848
    s_cmov_b32 s0, 6346752
    s_mov_b32 s1, 6355968
    s_cmov_b32 s1, 6354944
    s_mov_b32 s30, 6362112
    s_cmov_b32 s30, 6356992
    s_add_u32 s0, s0, s41
    s_add_u32 s1, s1, s41
    s_add_u32 s30, s30, s41
    s_lshl1_add_u32 s43, s43, s42
    s_lshl1_add_u32 s98, s99, s79
    s_lshl2_add_u32 s40, s43, s98
    s_lshl_b32 s97, s40, 6
    s_add_u32 s97, s97, 17825792
    s_mul_i32 s48, s40, 20480
    s_mul_i32 s98, s44, 160
    s_add_u32 s48, s48, s98
    s_lshl_b32 s98, s44, 7
    s_add_u32 s40, s40, s98
    s_mul_i32 s49, s40, 5120
    s_add_u32 s49, s49, 18874368
    s_xor_b32 s40, s40, 4
    s_mul_i32 s52, s40, 5120
    s_add_u32 s52, s52, 18874368
    s_mov_b32 s55, 0x07060500
    s_and_b32 s53, s100, 0xff
    s_mul_i32 s53, s53, 0x101
    s_mov_b32 s20, 0x3fb8aa3b
    s_mov_b32 s21, 0x3fb8aa3b
    s_mul_i32 s98, s68, 6144
    s_add_u32 s98, s98, 81920
    v_add_u32 v0, s98, v2
    s_mul_i32 s22, s64, 12288
    s_add_u32 s22, s22, s69
    s_add_u32 s22, s22, 2686976
    s_waitcnt lgkmcnt(10)
    v_mfma_f32_32x32x16_bf16 v[48:63], v[28:31], v[128:131], v[48:63]
    s_add_u32 m0, s69, 32768
    s_nop 0
    buffer_load_dwordx4 v65, s[4:7], s71 offen offset:1024 lds
    s_add_u32 s70, s70, 1
    s_cmp_eq_u32 s70, 10
    s_mov_b32 s98, 128
    s_cmov_b32 s98, -1152
    s_cselect_b32 s70, 0, s70
    s_add_u32 s71, s71, s98
    ds_read_b128 v[140:143], v75 offset:0
    ds_read_b64_tr_b16 v[24:25], v81 offset:28672
    ds_read_b64_tr_b16 v[26:27], v81 offset:29696
    ds_read_b64_tr_b16 v[28:29], v81 offset:28928
    ds_read_b64_tr_b16 v[30:31], v81 offset:29952
    s_waitcnt lgkmcnt(12)
    v_mfma_f32_32x32x16_bf16 v[32:47], v[8:11], v[132:135], v[32:47]
    s_add_u32 m0, s69, 49152
    s_nop 0
    buffer_load_dwordx4 v66, s[8:11], s72 offen lds
    s_waitcnt lgkmcnt(10)
    v_mfma_f32_32x32x16_bf16 v[48:63], v[12:15], v[132:135], v[48:63]
    s_add_u32 m0, s69, 49152
    s_nop 0
    buffer_load_dwordx4 v67, s[8:11], s72 offen offset:1024 lds
    s_add_u32 s34, s34, 1
    s_cmp_eq_u32 s34, 10
    s_mov_b32 s98, 221184
    s_cmov_b32 s98, -1990656
    s_cselect_b32 s34, 0, s34
    s_add_u32 s72, s72, s98
    s_waitcnt lgkmcnt(0)
    v_mfma_f32_32x32x16_bf16 v[32:47], v[16:19], v[136:139], v[32:47]
    v_mfma_f32_32x32x16_bf16 v[48:63], v[20:23], v[136:139], v[48:63]
    s_waitcnt vmcnt(5)
    s_barrier
    s_lshl_b32 s40, s64, 4
    s_add_u32 s40, s40, s63
    s_lshl_b32 s40, s40, 7
    s_add_u32 s40, s40, 17891328
    s_cmp_eq_u32 s62, 0
    s_cselect_b32 s40, s40, s101
    v_mov_b32 v84, s100
    v_lshlrev_b32 v85, 2, v1
    s_cmp_eq_u32 s40, s101
    s_cselect_b32 exec_lo, 0, -1
    s_mov_b32 exec_hi, 0
    buffer_store_dword v84, v85, s[12:15], s40 offen sc1
    s_mov_b64 exec, -1
    ds_read_b128 v[144:147], v72 offset:32768
    ds_read_b64_tr_b16 v[8:9], v81 offset:49152
    ds_read_b64_tr_b16 v[10:11], v81 offset:50176
    ds_read_b64_tr_b16 v[12:13], v81 offset:49408
    ds_read_b64_tr_b16 v[14:15], v81 offset:50432
    s_add_u32 m0, s69, 65536
    s_nop 0
    buffer_load_dwordx4 v64, s[4:7], s71 offen lds
    v_mfma_f32_32x32x16_bf16 v[32:47], v[24:27], v[140:143], v[32:47]
    s_add_u32 m0, s69, 65536
    s_nop 0
    buffer_load_dwordx4 v65, s[4:7], s71 offen offset:1024 lds
    s_add_u32 s70, s70, 1
    s_cmp_eq_u32 s70, 10
    s_mov_b32 s98, 128
    s_cmov_b32 s98, -1152
    s_cselect_b32 s70, 0, s70
    s_add_u32 s71, s71, s98
    v_mfma_f32_32x32x16_bf16 v[48:63], v[28:31], v[140:143], v[48:63]
    s_add_u32 m0, s69, 81920
    s_nop 0
    buffer_load_dwordx4 v66, s[8:11], s72 offen lds
    ds_read_b128 v[148:151], v73 offset:32768
    ds_read_b64_tr_b16 v[16:17], v81 offset:53248
    ds_read_b64_tr_b16 v[18:19], v81 offset:54272
    ds_read_b64_tr_b16 v[20:21], v81 offset:53504
    ds_read_b64_tr_b16 v[22:23], v81 offset:54528
    ds_read_b128 v[152:155], v74 offset:32768
    ds_read_b64_tr_b16 v[24:25], v81 offset:57344
    ds_read_b64_tr_b16 v[26:27], v81 offset:58368
    ds_read_b64_tr_b16 v[28:29], v81 offset:57600
    ds_read_b64_tr_b16 v[30:31], v81 offset:58624
    s_waitcnt lgkmcnt(12)
    v_mfma_f32_32x32x16_bf16 v[32:47], v[8:11], v[144:147], v[32:47]
    s_add_u32 m0, s69, 81920
    s_nop 0
    buffer_load_dwordx4 v67, s[8:11], s72 offen offset:1024 lds
    s_add_u32 s34, s34, 1
    s_cmp_eq_u32 s34, 10
    s_mov_b32 s98, 221184
    s_cmov_b32 s98, -1990656
    s_cselect_b32 s34, 0, s34
    s_add_u32 s72, s72, s98
    s_waitcnt lgkmcnt(10)
    v_mfma_f32_32x32x16_bf16 v[48:63], v[12:15], v[144:147], v[48:63]
    s_lshl_b32 s98, s68, 9
    s_add_u32 s98, s98, s29
    buffer_store_dwordx4 v[236:239], v83, s[12:15], s98 offen sc1
    ds_read_b128 v[156:159], v75 offset:32768
    ds_read_b64_tr_b16 v[8:9], v81 offset:61440
    ds_read_b64_tr_b16 v[10:11], v81 offset:62464
    ds_read_b64_tr_b16 v[12:13], v81 offset:61696
    ds_read_b64_tr_b16 v[14:15], v81 offset:62720
    s_waitcnt lgkmcnt(12)
    v_mfma_f32_32x32x16_bf16 v[32:47], v[16:19], v[148:151], v[32:47]
    s_cmp_eq_u32 s68, 0
    s_cselect_b32 exec_lo, -1, 0
    s_mov_b32 exec_hi, 0
    buffer_store_dwordx4 v[236:239], v83, s[12:15], s29 offen offset:1024 sc1
    s_cmp_eq_u32 s23, s101
    s_cselect_b32 exec_lo, 0, 0xff
    buffer_store_dwordx4 v[236:239], v2, s[12:15], s23 offen sc1
    s_mov_b64 exec, -1
    s_waitcnt lgkmcnt(10)
    v_mfma_f32_32x32x16_bf16 v[48:63], v[20:23], v[148:151], v[48:63]
    s_waitcnt lgkmcnt(0)
    v_mfma_f32_32x32x16_bf16 v[32:47], v[24:27], v[152:155], v[32:47]
    v_mfma_f32_32x32x16_bf16 v[48:63], v[28:31], v[152:155], v[48:63]
    s_barrier
    ds_read_b128 v[160:163], v76 offset:0
    ds_read_b64_tr_b16 v[16:17], v82 offset:16384
    ds_read_b64_tr_b16 v[18:19], v82 offset:17408
    ds_read_b64_tr_b16 v[20:21], v82 offset:16640
    ds_read_b64_tr_b16 v[22:23], v82 offset:17664
    s_add_u32 m0, s69, 98304
    s_nop 0
    buffer_load_dwordx4 v64, s[4:7], s71 offen lds
    v_mfma_f32_32x32x16_bf16 v[32:47], v[8:11], v[156:159], v[32:47]
    v_mfma_f32_32x32x16_bf16 v[48:63], v[12:15], v[156:159], v[48:63]
    s_add_u32 m0, s69, 98304
    s_nop 0
    buffer_load_dwordx4 v65, s[4:7], s71 offen offset:1024 lds
    s_add_u32 s70, s70, 1
    s_cmp_eq_u32 s70, 10
    s_mov_b32 s98, 128
    s_cmov_b32 s98, -1152
    s_cselect_b32 s70, 0, s70
    s_add_u32 s71, s71, s98
    ds_read_b128 v[164:167], v77 offset:0
    ds_read_b64_tr_b16 v[24:25], v82 offset:20480
    ds_read_b64_tr_b16 v[26:27], v82 offset:21504
    ds_read_b64_tr_b16 v[28:29], v82 offset:20736
    ds_read_b64_tr_b16 v[30:31], v82 offset:21760
    ds_read_b128 v[168:171], v78 offset:0
    ds_read_b64_tr_b16 v[8:9], v82 offset:24576
    ds_read_b64_tr_b16 v[10:11], v82 offset:25600
    ds_read_b64_tr_b16 v[12:13], v82 offset:24832
    ds_read_b64_tr_b16 v[14:15], v82 offset:25856
    s_waitcnt lgkmcnt(12)
    v_mfma_f32_32x32x16_bf16 v[32:47], v[16:19], v[160:163], v[32:47]
    s_waitcnt lgkmcnt(10)
    v_mfma_f32_32x32x16_bf16 v[48:63], v[20:23], v[160:163], v[48:63]
    s_add_u32 m0, s69, 114688
    s_nop 0
    buffer_load_dwordx4 v66, s[8:11], s72 offen lds
    ds_read_b128 v[172:175], v79 offset:0
    ds_read_b64_tr_b16 v[16:17], v82 offset:28672
    ds_read_b64_tr_b16 v[18:19], v82 offset:29696
    ds_read_b64_tr_b16 v[20:21], v82 offset:28928
    ds_read_b64_tr_b16 v[22:23], v82 offset:29952
    s_waitcnt lgkmcnt(12)
    v_mfma_f32_32x32x16_bf16 v[32:47], v[24:27], v[164:167], v[32:47]
    s_waitcnt lgkmcnt(10)
    v_mfma_f32_32x32x16_bf16 v[48:63], v[28:31], v[164:167], v[48:63]
    s_add_u32 m0, s69, 114688
    s_nop 0
    buffer_load_dwordx4 v67, s[8:11], s72 offen offset:1024 lds
    s_add_u32 s34, s34, 1
    s_cmp_eq_u32 s34, 10
    s_mov_b32 s98, 221184
    s_cmov_b32 s98, -1990656
    s_cselect_b32 s34, 0, s34
    s_add_u32 s72, s72, s98
    s_waitcnt lgkmcnt(0)
    v_mfma_f32_32x32x16_bf16 v[32:47], v[8:11], v[168:171], v[32:47]
    v_mfma_f32_32x32x16_bf16 v[48:63], v[12:15], v[168:171], v[48:63]
    s_waitcnt vmcnt(16)
    s_barrier
    s_lshl_b32 s31, s64, 11
    s_add_u32 s31, s31, 17891328
    v_and_b32 v6, 15, v1
    v_lshl_add_u32 v6, v6, 7, s31
    s_cmp_lg_u32 s62, 3
    s_cselect_b64 exec, 0, -1
    buffer_load_dword v7, v6, s[12:15], 0 offen sc1
    s_mov_b64 exec, -1
    ds_read_b128 v[176:179], v68 offset:0
    ds_read_b64_tr_b16 v[24:25], v80 offset:16384
    ds_read_b64_tr_b16 v[26:27], v80 offset:17408
    ds_read_b64_tr_b16 v[28:29], v80 offset:16640
    ds_read_b64_tr_b16 v[30:31], v80 offset:17664
    s_add_u32 m0, s69, 131072
    s_nop 0
    buffer_load_dwordx4 v64, s[4:7], s71 offen lds
    v_mfma_f32_32x32x16_bf16 v[32:47], v[16:19], v[172:175], v[32:47]
    v_mfma_f32_32x32x16_bf16 v[48:63], v[20:23], v[172:175], v[48:63]
    s_add_u32 m0, s69, 131072
    s_nop 0
    buffer_load_dwordx4 v65, s[4:7], s71 offen offset:1024 lds
    ds_read_b128 v[180:183], v69 offset:0
    ds_read_b64_tr_b16 v[8:9], v80 offset:20480
    ds_read_b64_tr_b16 v[10:11], v80 offset:21504
    ds_read_b64_tr_b16 v[12:13], v80 offset:20736
    ds_read_b64_tr_b16 v[14:15], v80 offset:21760
    ds_read_b128 v[184:187], v70 offset:0
    ds_read_b64_tr_b16 v[16:17], v80 offset:24576
    ds_read_b64_tr_b16 v[18:19], v80 offset:25600
    ds_read_b64_tr_b16 v[20:21], v80 offset:24832
    ds_read_b64_tr_b16 v[22:23], v80 offset:25856
    s_waitcnt lgkmcnt(12)
    v_mfma_f32_32x32x16_bf16 v[32:47], v[24:27], v[176:179], v[32:47]
    s_waitcnt lgkmcnt(10)
    v_mfma_f32_32x32x16_bf16 v[48:63], v[28:31], v[176:179], v[48:63]
    s_add_u32 m0, s69, 147456
    s_nop 0
    buffer_load_dwordx4 v66, s[8:11], s72 offen lds
    ds_read_b128 v[188:191], v71 offset:0
    ds_read_b64_tr_b16 v[24:25], v80 offset:28672
    ds_read_b64_tr_b16 v[26:27], v80 offset:29696
    ds_read_b64_tr_b16 v[28:29], v80 offset:28928
    ds_read_b64_tr_b16 v[30:31], v80 offset:29952
    s_waitcnt lgkmcnt(12)
    v_mfma_f32_32x32x16_bf16 v[32:47], v[8:11], v[180:183], v[32:47]
    s_waitcnt lgkmcnt(10)
    v_mfma_f32_32x32x16_bf16 v[48:63], v[12:15], v[180:183], v[48:63]
    s_add_u32 m0, s69, 147456
    s_nop 0
    buffer_load_dwordx4 v67, s[8:11], s72 offen offset:1024 lds
    s_waitcnt lgkmcnt(0)
    v_mfma_f32_32x32x16_bf16 v[32:47], v[16:19], v[184:187], v[32:47]
    v_mfma_f32_32x32x16_bf16 v[48:63], v[20:23], v[184:187], v[48:63]
    s_waitcnt vmcnt(17)
    s_barrier
    s_cmp_lg_u32 s62, 3
    s_cselect_b64 exec, 0, -1
    buffer_load_dword v94, v6, s[12:15], 0 offen sc1
    s_mov_b64 exec, -1
    ds_read_b128 v[192:195], v68 offset:32768
    ds_read_b64_tr_b16 v[8:9], v80 offset:49152
    ds_read_b64_tr_b16 v[10:11], v80 offset:50176
    ds_read_b64_tr_b16 v[12:13], v80 offset:49408
    ds_read_b64_tr_b16 v[14:15], v80 offset:50432
    s_mul_i32 m0, s62, 640
    s_add_u32 m0, m0, 16384
    s_mov_b32 exec_hi, 0xff
    buffer_load_dwordx4 v95, s[24:27], s28 offen lds
    s_mov_b32 exec_hi, -1
    v_mfma_f32_32x32x16_bf16 v[32:47], v[24:27], v[188:191], v[32:47]
    v_mfma_f32_32x32x16_bf16 v[48:63], v[28:31], v[188:191], v[48:63]
    s_mul_i32 m0, s62, 640
    s_add_u32 m0, m0, 21504
    s_add_u32 s98, s28, 1310720
    s_mov_b32 exec_hi, 0xff
    buffer_load_dwordx4 v95, s[24:27], s98 offen lds
    s_mov_b32 exec_hi, -1
    ds_read_b128 v[196:199], v69 offset:32768
    ds_read_b64_tr_b16 v[16:17], v80 offset:53248
    ds_read_b64_tr_b16 v[18:19], v80 offset:54272
    ds_read_b64_tr_b16 v[20:21], v80 offset:53504
    ds_read_b64_tr_b16 v[22:23], v80 offset:54528
    ds_read_b128 v[200:203], v70 offset:32768
    ds_read_b64_tr_b16 v[24:25], v80 offset:57344
    ds_read_b64_tr_b16 v[26:27], v80 offset:58368
    ds_read_b64_tr_b16 v[28:29], v80 offset:57600
    ds_read_b64_tr_b16 v[30:31], v80 offset:58624
    s_waitcnt lgkmcnt(12)
    v_mfma_f32_32x32x16_bf16 v[32:47], v[8:11], v[192:195], v[32:47]
    s_waitcnt lgkmcnt(10)
    v_mfma_f32_32x32x16_bf16 v[48:63], v[12:15], v[192:195], v[48:63]
    s_mul_i32 m0, s62, 640
    s_add_u32 m0, m0, 26624
    s_mov_b64 s[36:37], s[60:61]
    s_mov_b32 s38, 819200
    s_mov_b32 exec_hi, 0xff
    buffer_load_dwordx4 v95, s[36:39], s3 offen lds
    s_mov_b32 exec_hi, -1
    ds_read_b128 v[204:207], v71 offset:32768
    ds_read_b64_tr_b16 v[8:9], v80 offset:61440
    ds_read_b64_tr_b16 v[10:11], v80 offset:62464
    ds_read_b64_tr_b16 v[12:13], v80 offset:61696
    ds_read_b64_tr_b16 v[14:15], v80 offset:62720
    s_waitcnt lgkmcnt(12)
    v_mfma_f32_32x32x16_bf16 v[32:47], v[16:19], v[196:199], v[32:47]
    s_waitcnt lgkmcnt(10)
    v_mfma_f32_32x32x16_bf16 v[48:63], v[20:23], v[196:199], v[48:63]
    s_waitcnt lgkmcnt(0)
    v_mfma_f32_32x32x16_bf16 v[32:47], v[24:27], v[200:203], v[32:47]
    v_mfma_f32_32x32x16_bf16 v[48:63], v[28:31], v[200:203], v[48:63]
    s_cmp_lg_u32 s62, 3
    s_cbranch_scc1 L_PD_2
    s_waitcnt vmcnt(8)
    v_cmp_ne_u32 vcc, s100, v7
    s_mov_b32 s76, 4000
    s_cbranch_vccz L_PD_2
    s_waitcnt vmcnt(3)
    v_cmp_ne_u32 vcc, s100, v94
    s_mov_b32 s76, 4000
    s_cbranch_vccz L_PD_2
L_PL_1:
    s_sleep 1
    buffer_load_dword v94, v6, s[12:15], 0 offen sc1
    s_waitcnt vmcnt(0)
    s_sub_u32 s76, s76, 1
    s_cmp_eq_u32 s76, 0
    s_cbranch_scc1 L_PD_2
    v_cmp_ne_u32 vcc, s100, v94
    s_cbranch_vccnz L_PL_1
L_PD_2:
    s_waitcnt vmcnt(16)
    s_barrier
    ds_read_b128 v[208:211], v72 offset:0
    ds_read_b64_tr_b16 v[16:17], v81 offset:16384
    ds_read_b64_tr_b16 v[18:19], v81 offset:17408
    ds_read_b64_tr_b16 v[20:21], v81 offset:16640
    ds_read_b64_tr_b16 v[22:23], v81 offset:17664
    s_add_u32 m0, s69, 0
    s_nop 0
    buffer_load_dwordx4 v2, s[12:15], s73 offen sc1 lds
    v_mfma_f32_32x32x16_bf16 v[32:47], v[8:11], v[204:207], v[32:47]
    v_mfma_f32_32x32x16_bf16 v[48:63], v[12:15], v[204:207], v[48:63]
    s_add_u32 m0, s69, 0
    s_nop 0
    buffer_load_dwordx4 v2, s[12:15], s73 offen offset:1024 sc1 lds
    s_add_u32 s74, s74, 1
    s_cmp_eq_u32 s74, 10
    s_mov_b32 s98, 16384
    s_cmov_b32 s98, -147456
    s_cselect_b32 s74, 0, s74
    s_add_u32 s73, s73, s98
    ds_read_b128 v[212:215], v73 offset:0
    ds_read_b64_tr_b16 v[24:25], v81 offset:20480
    ds_read_b64_tr_b16 v[26:27], v81 offset:21504
    ds_read_b64_tr_b16 v[28:29], v81 offset:20736
    ds_read_b64_tr_b16 v[30:31], v81 offset:21760
    ds_read_b128 v[216:219], v74 offset:0
    ds_read_b64_tr_b16 v[8:9], v81 offset:24576
    ds_read_b64_tr_b16 v[10:11], v81 offset:25600
    ds_read_b64_tr_b16 v[12:13], v81 offset:24832
    ds_read_b64_tr_b16 v[14:15], v81 offset:25856
    s_waitcnt lgkmcnt(12)
    v_mfma_f32_32x32x16_bf16 v[32:47], v[16:19], v[208:211], v[32:47]
    v_lshrrev_b32 v6, 4, v1
    s_waitcnt vmcnt(10)
    v_bfe_u32 v7, v1, 2, 2
    v_lshl_add_u32 v6, v6, 3, v7
    v_mul_u32_u24 v6, 160, v6
    v_and_b32 v7, 3, v1
    s_waitcnt lgkmcnt(10)
    v_mfma_f32_32x32x16_bf16 v[48:63], v[20:23], v[208:211], v[48:63]
    v_lshl_add_u32 v6, v7, 3, v6
    v_add_u32 v7, s59, v6
    v_add_u32 v6, s58, v6
    ds_read_b128 v[220:223], v75 offset:0
    ds_read_b64_tr_b16 v[16:17], v81 offset:28672
    ds_read_b64_tr_b16 v[18:19], v81 offset:29696
    ds_read_b64_tr_b16 v[20:21], v81 offset:28928
    ds_read_b64_tr_b16 v[22:23], v81 offset:29952
    s_waitcnt lgkmcnt(12)
    v_mfma_f32_32x32x16_bf16 v[32:47], v[24:27], v[212:215], v[32:47]
    s_waitcnt lgkmcnt(10)
    v_mfma_f32_32x32x16_bf16 v[48:63], v[28:31], v[212:215], v[48:63]
    s_waitcnt lgkmcnt(0)
    v_mfma_f32_32x32x16_bf16 v[32:47], v[8:11], v[216:219], v[32:47]
    v_mfma_f32_32x32x16_bf16 v[48:63], v[12:15], v[216:219], v[48:63]
    s_barrier
    ds_read_b128 v[224:227], v72 offset:32768
    ds_read_b64_tr_b16 v[24:25], v81 offset:49152
    ds_read_b64_tr_b16 v[26:27], v81 offset:50176
    ds_read_b64_tr_b16 v[28:29], v81 offset:49408
    ds_read_b64_tr_b16 v[30:31], v81 offset:50432
    s_add_u32 m0, s69, 32768
    s_nop 0
    buffer_load_dwordx4 v2, s[12:15], s73 offen sc1 lds
    v_mfma_f32_32x32x16_bf16 v[32:47], v[16:19], v[220:223], v[32:47]
    v_mfma_f32_32x32x16_bf16 v[48:63], v[20:23], v[220:223], v[48:63]
    s_add_u32 m0, s69, 32768
    s_nop 0
    buffer_load_dwordx4 v2, s[12:15], s73 offen offset:1024 sc1 lds
    s_add_u32 s74, s74, 1
    s_cmp_eq_u32 s74, 10
    s_mov_b32 s98, 16384
    s_cmov_b32 s98, -147456
    s_cselect_b32 s74, 0, s74
    s_add_u32 s73, s73, s98
    ds_read_b128 v[228:231], v73 offset:32768
    ds_read_b64_tr_b16 v[8:9], v81 offset:53248
    ds_read_b64_tr_b16 v[10:11], v81 offset:54272
    ds_read_b64_tr_b16 v[12:13], v81 offset:53504
    ds_read_b64_tr_b16 v[14:15], v81 offset:54528
    ds_read_b128 v[232:235], v74 offset:32768
    ds_read_b64_tr_b16 v[16:17], v81 offset:57344
    ds_read_b64_tr_b16 v[18:19], v81 offset:58368
    ds_read_b64_tr_b16 v[20:21], v81 offset:57600
    ds_read_b64_tr_b16 v[22:23], v81 offset:58624
    s_waitcnt lgkmcnt(12)
    v_mfma_f32_32x32x16_bf16 v[32:47], v[24:27], v[224:227], v[32:47]
    s_waitcnt lgkmcnt(10)
    v_mfma_f32_32x32x16_bf16 v[48:63], v[28:31], v[224:227], v[48:63]
    ds_read_b128 v[236:239], v75 offset:32768
    ds_read_b64_tr_b16 v[24:25], v81 offset:61440
    ds_read_b64_tr_b16 v[26:27], v81 offset:62464
    ds_read_b64_tr_b16 v[28:29], v81 offset:61696
    ds_read_b64_tr_b16 v[30:31], v81 offset:62720
    s_waitcnt lgkmcnt(12)
    v_mfma_f32_32x32x16_bf16 v[32:47], v[8:11], v[228:231], v[32:47]
    s_waitcnt lgkmcnt(10)
    v_mfma_f32_32x32x16_bf16 v[48:63], v[12:15], v[228:231], v[48:63]
    s_waitcnt lgkmcnt(0)
    v_mfma_f32_32x32x16_bf16 v[32:47], v[16:19], v[232:235], v[32:47]
    v_mfma_f32_32x32x16_bf16 v[48:63], v[20:23], v[232:235], v[48:63]
    s_waitcnt vmcnt(4)
    s_barrier
    ds_read_b64_tr_b16 v[84:85], v6 offset:0
    ds_read_b64_tr_b16 v[86:87], v6 offset:640
    ds_read_b64_tr_b16 v[88:89], v7 offset:0
    ds_read_b64_tr_b16 v[90:91], v7 offset:640
    ds_read_b128 v[240:243], v76 offset:0
    ds_read_b64_tr_b16 v[8:9], v82 offset:16384
    ds_read_b64_tr_b16 v[10:11], v82 offset:17408
    ds_read_b64_tr_b16 v[12:13], v82 offset:16640
    ds_read_b64_tr_b16 v[14:15], v82 offset:17664
    v_mfma_f32_32x32x16_bf16 v[32:47], v[24:27], v[236:239], v[32:47]
    s_waitcnt lgkmcnt(7)
    buffer_store_dwordx4 v[84:87], v2, s[12:15], s77 offen sc1
    s_waitcnt lgkmcnt(5)
    buffer_store_dwordx4 v[88:91], v2, s[12:15], s78 offen sc1
    v_mfma_f32_32x32x16_bf16 v[48:63], v[28:31], v[236:239], v[48:63]
    ds_read_b128 v[244:247], v77 offset:0
    ds_read_b64_tr_b16 v[16:17], v82 offset:20480
    ds_read_b64_tr_b16 v[18:19], v82 offset:21504
    ds_read_b64_tr_b16 v[20:21], v82 offset:20736
    ds_read_b64_tr_b16 v[22:23], v82 offset:21760
    ds_read_b128 v[248:251], v78 offset:0
    ds_read_b64_tr_b16 v[24:25], v82 offset:24576
    ds_read_b64_tr_b16 v[26:27], v82 offset:25600
    ds_read_b64_tr_b16 v[28:29], v82 offset:24832
    ds_read_b64_tr_b16 v[30:31], v82 offset:25856
    s_waitcnt lgkmcnt(12)
    v_mfma_f32_32x32x16_bf16 v[32:47], v[8:11], v[240:243], v[32:47]
    v_mov_b32 v7, v83
    s_waitcnt lgkmcnt(10)
    v_mfma_f32_32x32x16_bf16 v[48:63], v[12:15], v[240:243], v[48:63]
    ds_read_b128 v[252:255], v79 offset:0
    ds_read_b64_tr_b16 v[8:9], v82 offset:28672
    ds_read_b64_tr_b16 v[10:11], v82 offset:29696
    ds_read_b64_tr_b16 v[12:13], v82 offset:28928
    ds_read_b64_tr_b16 v[14:15], v82 offset:29952
    s_waitcnt lgkmcnt(12)
    v_mfma_f32_32x32x16_bf16 v[32:47], v[16:19], v[244:247], v[32:47]
    s_waitcnt lgkmcnt(10)
    v_mfma_f32_32x32x16_bf16 v[48:63], v[20:23], v[244:247], v[48:63]
    s_waitcnt lgkmcnt(0)
    v_mfma_f32_32x32x16_bf16 v[32:47], v[24:27], v[248:251], v[32:47]
    v_mfma_f32_32x32x16_bf16 v[48:63], v[28:31], v[248:251], v[48:63]
    s_waitcnt vmcnt(4)
    s_barrier
    ds_read_b128 v[16:19], v3 offset:0
    ds_read_b128 v[20:23], v3 offset:1024
    s_add_u32 m0, s69, 49152
    s_nop 0
    buffer_load_dwordx4 v2, s[12:15], s73 offen sc1 lds
    v_mfma_f32_32x32x16_bf16 v[32:47], v[8:11], v[252:255], v[32:47]
    v_mfma_f32_32x32x16_bf16 v[48:63], v[12:15], v[252:255], v[48:63]
    s_add_u32 m0, s69, 49152
    s_nop 0
    buffer_load_dwordx4 v2, s[12:15], s73 offen offset:1024 sc1 lds
    s_add_u32 s74, s74, 1
    s_cmp_eq_u32 s74, 10
    s_mov_b32 s98, 16384
    s_cmov_b32 s98, -147456
    s_cselect_b32 s74, 0, s74
    s_add_u32 s73, s73, s98
    ds_read_b128 v[24:27], v3 offset:4096
    ds_read_b128 v[28:31], v3 offset:5120
    ds_read_b128 v[8:11], v3 offset:8192
    ds_read_b128 v[12:15], v3 offset:9216
    s_waitcnt lgkmcnt(5)
    v_mfma_f32_32x32x16_bf16 v[64:79], v[16:19], v[96:99], 0
    s_cmp_eq_u32 s68, 0
    s_cselect_b64 s[4:5], -1, 0
    s_cmp_eq_u32 s79, 0
    s_cselect_b64 s[8:9], 0, -1
    s_mov_b32 s3, 0x0c0c0400
    s_cmp_lt_u32 s62, 6
    s_cselect_b64 s[6:7], -1, 0
    s_waitcnt lgkmcnt(4)
    v_mfma_f32_32x32x16_bf16 v[80:95], v[20:23], v[96:99], 0
    s_add_u32 m0, s69, 16384
    s_nop 0
    buffer_load_dwordx4 v2, s[12:15], s73 offen sc1 lds
    ds_read_b128 v[16:19], v3 offset:12288
    ds_read_b128 v[20:23], v3 offset:13312
    s_waitcnt lgkmcnt(5)
    v_mfma_f32_32x32x16_bf16 v[64:79], v[24:27], v[100:103], v[64:79]
    s_waitcnt lgkmcnt(4)
    v_mfma_f32_32x32x16_bf16 v[80:95], v[28:31], v[100:103], v[80:95]
    s_add_u32 m0, s69, 16384
    s_nop 0
    buffer_load_dwordx4 v2, s[12:15], s73 offen offset:1024 sc1 lds
    s_add_u32 s74, s74, 1
    s_cmp_eq_u32 s74, 10
    s_mov_b32 s98, 16384
    s_cmov_b32 s98, -147456
    s_cselect_b32 s74, 0, s74
    s_add_u32 s73, s73, s98
    s_waitcnt lgkmcnt(0)
    v_mfma_f32_32x32x16_bf16 v[64:79], v[8:11], v[104:107], v[64:79]
    v_mfma_f32_32x32x16_bf16 v[80:95], v[12:15], v[104:107], v[80:95]
    s_waitcnt vmcnt(4)
    s_barrier
    s_lshl_b32 s40, s66, 5
    s_add_u32 s40, s40, s65
    s_lshl_b32 s40, s40, 7
    s_add_u32 s40, s40, 17924096
    s_cmp_eq_u32 s62, 0
    s_cselect_b32 s40, s40, s101
    v_mov_b32 v104, s100
    v_lshlrev_b32 v105, 2, v1
    s_cmp_eq_u32 s40, s101
    s_cselect_b32 exec_lo, 0, -1
    s_mov_b32 exec_hi, 0
    buffer_store_dword v104, v105, s[12:15], s40 offen sc1
    s_mov_b64 exec, -1
    ds_read_b128 v[24:27], v3 offset:32768
    ds_read_b128 v[28:31], v3 offset:33792
    s_add_u32 m0, s69, 65536
    s_nop 0
    buffer_load_dwordx4 v2, s[12:15], s73 offen sc1 lds
    v_mfma_f32_32x32x16_bf16 v[64:79], v[16:19], v[108:111], v[64:79]
    v_mul_f32 v96, s32, v32
    v_mul_f32 v97, s32, v33
    v_mul_f32 v98, s32, v34
    v_mul_f32 v99, s32, v35
    v_mul_f32 v100, s32, v36
    v_mul_f32 v101, s32, v37
    v_mul_f32 v102, s32, v38
    v_mul_f32 v103, s32, v39
    v_exp_f32 v96, v96
    v_mfma_f32_32x32x16_bf16 v[80:95], v[20:23], v[108:111], v[80:95]
    s_add_u32 m0, s69, 65536
    s_nop 0
    buffer_load_dwordx4 v2, s[12:15], s73 offen offset:1024 sc1 lds
    s_add_u32 s74, s74, 1
    s_cmp_eq_u32 s74, 10
    s_mov_b32 s98, 16384
    s_cmov_b32 s98, -147456
    s_cselect_b32 s74, 0, s74
    s_add_u32 s73, s73, s98
    v_exp_f32 v97, v97
    v_exp_f32 v98, v98
    v_add_f32 v96, 1.0, v96
    v_exp_f32 v99, v99
    v_add_f32 v97, 1.0, v97
    v_exp_f32 v100, v100
    ds_read_b128 v[8:11], v3 offset:36864
    ds_read_b128 v[12:15], v3 offset:37888
    ds_read_b128 v[16:19], v3 offset:40960
    ds_read_b128 v[20:23], v3 offset:41984
    s_waitcnt lgkmcnt(5)
    v_mfma_f32_32x32x16_bf16 v[64:79], v[24:27], v[112:115], v[64:79]
    v_add_f32 v98, 1.0, v98
    v_exp_f32 v101, v101
    v_add_f32 v99, 1.0, v99
    v_exp_f32 v102, v102
    v_add_f32 v100, 1.0, v100
    v_exp_f32 v103, v103
    v_add_f32 v101, 1.0, v101
    s_waitcnt lgkmcnt(4)
    v_mfma_f32_32x32x16_bf16 v[80:95], v[28:31], v[112:115], v[80:95]
    v_add_f32 v102, 1.0, v102
    v_rcp_f32 v96, v96
    v_add_f32 v103, 1.0, v103
    v_rcp_f32 v97, v97
    v_rcp_f32 v98, v98
    v_mul_f32 v96, v96, v32
    ds_read_b128 v[24:27], v3 offset:45056
    ds_read_b128 v[28:31], v3 offset:46080
    s_waitcnt lgkmcnt(5)
    v_mfma_f32_32x32x16_bf16 v[64:79], v[8:11], v[116:119], v[64:79]
    v_rcp_f32 v99, v99
    v_mul_f32 v97, v97, v33
    v_rcp_f32 v100, v100
    v_mul_f32 v98, v98, v34
    v_rcp_f32 v101, v101
    v_mul_f32 v99, v99, v35
    s_waitcnt lgkmcnt(4)
    v_mfma_f32_32x32x16_bf16 v[80:95], v[12:15], v[116:119], v[80:95]
    v_rcp_f32 v102, v102
    v_mul_f32 v100, v100, v36
    v_rcp_f32 v103, v103
    v_mul_f32 v101, v101, v37
    v_mul_f32 v102, v102, v38
    v_mul_f32 v103, v103, v39
    v_cvt_pk_bf16_f32 v32, v96, v97
    v_cvt_pk_bf16_f32 v33, v98, v99
    s_waitcnt lgkmcnt(0)
    v_mfma_f32_32x32x16_bf16 v[64:79], v[16:19], v[120:123], v[64:79]
    v_cvt_pk_bf16_f32 v34, v100, v101
    v_cvt_pk_bf16_f32 v35, v102, v103
    s_cmp_eq_u32 s75, s101
    s_cselect_b64 exec, 0, -1
    buffer_store_dwordx4 v[32:35], v7, s[12:15], s75 offen offset:0 sc1
    s_mov_b64 exec, -1
    v_mul_f32 v104, s32, v40
    v_mul_f32 v105, s32, v41
    v_mul_f32 v106, s32, v42
    v_mul_f32 v107, s32, v43
    v_mfma_f32_32x32x16_bf16 v[80:95], v[20:23], v[120:123], v[80:95]
    v_mul_f32 v108, s32, v44
    v_mul_f32 v109, s32, v45
    v_mul_f32 v110, s32, v46
    v_mul_f32 v111, s32, v47
    v_exp_f32 v104, v104
    v_exp_f32 v105, v105
    v_exp_f32 v106, v106
    s_waitcnt vmcnt(6)
    s_barrier
    ds_read_b128 v[8:11], v3 offset:49152
    ds_read_b128 v[12:15], v3 offset:50176
    s_add_u32 m0, s69, 81920
    s_nop 0
    buffer_load_dwordx4 v2, s[12:15], s73 offen sc1 lds
    v_mfma_f32_32x32x16_bf16 v[64:79], v[24:27], v[124:127], v[64:79]
    v_add_f32 v104, 1.0, v104
    v_exp_f32 v107, v107
    v_add_f32 v105, 1.0, v105
    v_exp_f32 v108, v108
    v_add_f32 v106, 1.0, v106
    v_exp_f32 v109, v109
    v_add_f32 v107, 1.0, v107
    v_mfma_f32_32x32x16_bf16 v[80:95], v[28:31], v[124:127], v[80:95]
    s_add_u32 m0, s69, 81920
    s_nop 0
    buffer_load_dwordx4 v2, s[12:15], s73 offen offset:1024 sc1 lds
    s_add_u32 s74, s74, 1
    s_cmp_eq_u32 s74, 10
    s_mov_b32 s98, 16384
    s_cmov_b32 s98, -147456
    s_cselect_b32 s74, 0, s74
    s_add_u32 s73, s73, s98
    v_exp_f32 v110, v110
    v_add_f32 v108, 1.0, v108
    v_exp_f32 v111, v111
    v_add_f32 v109, 1.0, v109
    v_add_f32 v110, 1.0, v110
    v_rcp_f32 v104, v104
    v_add_f32 v111, 1.0, v111
    ds_read_b128 v[16:19], v3 offset:53248
    ds_read_b128 v[20:23], v3 offset:54272
    ds_read_b128 v[24:27], v3 offset:57344
    ds_read_b128 v[28:31], v3 offset:58368
    s_waitcnt lgkmcnt(5)
    v_mfma_f32_32x32x16_bf16 v[64:79], v[8:11], v[128:131], v[64:79]
    v_rcp_f32 v105, v105
    v_rcp_f32 v106, v106
    v_mul_f32 v104, v104, v40
    v_rcp_f32 v107, v107
    v_mul_f32 v105, v105, v41
    v_rcp_f32 v108, v108
    s_waitcnt lgkmcnt(4)
    v_mfma_f32_32x32x16_bf16 v[80:95], v[12:15], v[128:131], v[80:95]
    v_mul_f32 v106, v106, v42
    v_rcp_f32 v109, v109
    v_mul_f32 v107, v107, v43
    v_rcp_f32 v110, v110
    v_mul_f32 v108, v108, v44
    v_rcp_f32 v111, v111
    v_mul_f32 v109, v109, v45
    ds_read_b128 v[8:11], v3 offset:61440
    ds_read_b128 v[12:15], v3 offset:62464
    s_waitcnt lgkmcnt(5)
    v_mfma_f32_32x32x16_bf16 v[64:79], v[16:19], v[132:135], v[64:79]
    v_mul_f32 v110, v110, v46
    v_mul_f32 v111, v111, v47
    v_cvt_pk_bf16_f32 v40, v104, v105
    v_cvt_pk_bf16_f32 v41, v106, v107
    v_cvt_pk_bf16_f32 v42, v108, v109
    v_cvt_pk_bf16_f32 v43, v110, v111
    s_cmp_eq_u32 s75, s101
    s_cselect_b64 exec, 0, -1
    buffer_store_dwordx4 v[40:43], v7, s[12:15], s75 offen offset:512 sc1
    s_mov_b64 exec, -1
    s_waitcnt lgkmcnt(4)
    v_mfma_f32_32x32x16_bf16 v[80:95], v[20:23], v[132:135], v[80:95]
    v_mul_f32 v96, s32, v48
    v_mul_f32 v97, s32, v49
    v_mul_f32 v98, s32, v50
    v_mul_f32 v99, s32, v51
    v_mul_f32 v100, s32, v52
    v_mul_f32 v101, s32, v53
    v_mul_f32 v102, s32, v54
    v_mul_f32 v103, s32, v55
    v_exp_f32 v96, v96
    s_waitcnt lgkmcnt(0)
    v_mfma_f32_32x32x16_bf16 v[64:79], v[24:27], v[136:139], v[64:79]
    v_exp_f32 v97, v97
    v_exp_f32 v98, v98
    v_add_f32 v96, 1.0, v96
    v_exp_f32 v99, v99
    v_add_f32 v97, 1.0, v97
    v_exp_f32 v100, v100
    v_mfma_f32_32x32x16_bf16 v[80:95], v[28:31], v[136:139], v[80:95]
    v_add_f32 v98, 1.0, v98
    v_exp_f32 v101, v101
    v_add_f32 v99, 1.0, v99
    v_exp_f32 v102, v102
    v_add_f32 v100, 1.0, v100
    v_exp_f32 v103, v103
    v_add_f32 v101, 1.0, v101
    s_waitcnt vmcnt(7)
    s_barrier
    ds_read_b128 v[16:19], v3 offset:16384
    ds_read_b128 v[20:23], v3 offset:17408
    s_add_u32 m0, s69, 98304
    s_nop 0
    buffer_load_dwordx4 v2, s[12:15], s73 offen sc1 lds
    v_mfma_f32_32x32x16_bf16 v[64:79], v[8:11], v[140:143], v[64:79]
    v_add_f32 v102, 1.0, v102
    v_rcp_f32 v96, v96
    v_add_f32 v103, 1.0, v103
    v_rcp_f32 v97, v97
    v_rcp_f32 v98, v98
    v_mul_f32 v96, v96, v48
    v_mfma_f32_32x32x16_bf16 v[80:95], v[12:15], v[140:143], v[80:95]
    s_add_u32 m0, s69, 98304
    s_nop 0
    buffer_load_dwordx4 v2, s[12:15], s73 offen offset:1024 sc1 lds
    s_add_u32 s74, s74, 1
    s_cmp_eq_u32 s74, 10
    s_mov_b32 s98, 16384
    s_cmov_b32 s98, -147456
    s_cselect_b32 s74, 0, s74
    s_add_u32 s73, s73, s98
    v_rcp_f32 v99, v99
    v_mul_f32 v97, v97, v49
    v_rcp_f32 v100, v100
    v_mul_f32 v98, v98, v50
    v_rcp_f32 v101, v101
    v_mul_f32 v99, v99, v51
    ds_read_b128 v[24:27], v3 offset:20480
    ds_read_b128 v[28:31], v3 offset:21504
    ds_read_b128 v[8:11], v3 offset:24576
    ds_read_b128 v[12:15], v3 offset:25600
    s_waitcnt lgkmcnt(5)
    v_mfma_f32_32x32x16_bf16 v[64:79], v[16:19], v[144:147], v[64:79]
    v_rcp_f32 v102, v102
    v_mul_f32 v100, v100, v52
    v_rcp_f32 v103, v103
    v_mul_f32 v101, v101, v53
    v_mul_f32 v102, v102, v54
    v_mul_f32 v103, v103, v55
    v_cvt_pk_bf16_f32 v48, v96, v97
    v_cvt_pk_bf16_f32 v49, v98, v99
    s_waitcnt lgkmcnt(4)
    v_mfma_f32_32x32x16_bf16 v[80:95], v[20:23], v[144:147], v[80:95]
    v_cvt_pk_bf16_f32 v50, v100, v101
    v_cvt_pk_bf16_f32 v51, v102, v103
    s_cmp_eq_u32 s75, s101
    s_cselect_b64 exec, 0, -1
    buffer_store_dwordx4 v[48:51], v7, s[12:15], s75 offen offset:1024 sc1
    s_mov_b64 exec, -1
    v_mul_f32 v104, s32, v56
    v_mul_f32 v105, s32, v57
    v_mul_f32 v106, s32, v58
    v_mul_f32 v107, s32, v59
    ds_read_b128 v[16:19], v3 offset:28672
    ds_read_b128 v[20:23], v3 offset:29696
    s_waitcnt lgkmcnt(5)
    v_mfma_f32_32x32x16_bf16 v[64:79], v[24:27], v[148:151], v[64:79]
    v_mul_f32 v108, s32, v60
    v_mul_f32 v109, s32, v61
    v_mul_f32 v110, s32, v62
    v_mul_f32 v111, s32, v63
    v_exp_f32 v104, v104
    v_exp_f32 v105, v105
    v_exp_f32 v106, v106
    s_waitcnt lgkmcnt(4)
    v_mfma_f32_32x32x16_bf16 v[80:95], v[28:31], v[148:151], v[80:95]
    v_add_f32 v104, 1.0, v104
    v_exp_f32 v107, v107
    v_add_f32 v105, 1.0, v105
    v_exp_f32 v108, v108
    v_add_f32 v106, 1.0, v106
    v_exp_f32 v109, v109
    v_add_f32 v107, 1.0, v107
    s_waitcnt lgkmcnt(0)
    v_mfma_f32_32x32x16_bf16 v[64:79], v[8:11], v[152:155], v[64:79]
    v_exp_f32 v110, v110
    v_add_f32 v108, 1.0, v108
    v_exp_f32 v111, v111
    v_add_f32 v109, 1.0, v109
    v_add_f32 v110, 1.0, v110
    v_rcp_f32 v104, v104
    v_add_f32 v111, 1.0, v111
    v_mfma_f32_32x32x16_bf16 v[80:95], v[12:15], v[152:155], v[80:95]
    v_rcp_f32 v105, v105
    v_rcp_f32 v106, v106
    v_mul_f32 v104, v104, v56
    v_rcp_f32 v107, v107
    v_mul_f32 v105, v105, v57
    v_rcp_f32 v108, v108
    s_waitcnt vmcnt(7)
    s_barrier
    s_lshr_b32 s31, s2, 5
    s_lshl_b32 s31, s31, 12
    s_add_u32 s31, s31, 17924096
    v_and_b32 v112, 31, v1
    v_lshl_add_u32 v112, v112, 7, s31
    s_cmp_lg_u32 s62, 3
    s_cselect_b64 exec, 0, -1
    buffer_load_dword v113, v112, s[12:15], 0 offen sc1
    s_mov_b64 exec, -1
    ds_read_b128 v[24:27], v4 offset:0
    ds_read_b128 v[28:31], v4 offset:1024
    s_add_u32 m0, s69, 114688
    s_nop 0
    buffer_load_dwordx4 v2, s[12:15], s73 offen sc1 lds
    v_mfma_f32_32x32x16_bf16 v[64:79], v[16:19], v[156:159], v[64:79]
    v_mul_f32 v106, v106, v58
    v_rcp_f32 v109, v109
    v_mul_f32 v107, v107, v59
    v_rcp_f32 v110, v110
    v_mul_f32 v108, v108, v60
    v_rcp_f32 v111, v111
    v_mul_f32 v109, v109, v61
    v_mfma_f32_32x32x16_bf16 v[80:95], v[20:23], v[156:159], v[80:95]
    s_add_u32 m0, s69, 114688
    s_nop 0
    buffer_load_dwordx4 v2, s[12:15], s73 offen offset:1024 sc1 lds
    s_add_u32 s74, s74, 1
    s_cmp_eq_u32 s74, 10
    s_mov_b32 s98, 16384
    s_cmov_b32 s98, -147456
    s_cselect_b32 s74, 0, s74
    s_add_u32 s73, s73, s98
    v_mul_f32 v110, v110, v62
    v_mul_f32 v111, v111, v63
    v_cvt_pk_bf16_f32 v56, v104, v105
    v_cvt_pk_bf16_f32 v57, v106, v107
    v_cvt_pk_bf16_f32 v58, v108, v109
    v_cvt_pk_bf16_f32 v59, v110, v111
    s_cmp_eq_u32 s75, s101
    s_cselect_b64 exec, 0, -1
    buffer_store_dwordx4 v[56:59], v7, s[12:15], s75 offen offset:1536 sc1
    s_mov_b64 exec, -1
    ds_read_b128 v[8:11], v4 offset:4096
    ds_read_b128 v[12:15], v4 offset:5120
    ds_read_b128 v[16:19], v4 offset:8192
    ds_read_b128 v[20:23], v4 offset:9216
    s_waitcnt lgkmcnt(5)
    v_mfma_f32_32x32x16_bf16 v[64:79], v[24:27], v[160:163], v[64:79]
    s_waitcnt lgkmcnt(4)
    v_mfma_f32_32x32x16_bf16 v[80:95], v[28:31], v[160:163], v[80:95]
    ds_read_b128 v[24:27], v4 offset:12288
    ds_read_b128 v[28:31], v4 offset:13312
    s_waitcnt lgkmcnt(5)
    v_mfma_f32_32x32x16_bf16 v[64:79], v[8:11], v[164:167], v[64:79]
    s_waitcnt lgkmcnt(4)
    v_mfma_f32_32x32x16_bf16 v[80:95], v[12:15], v[164:167], v[80:95]
    s_waitcnt lgkmcnt(0)
    v_mfma_f32_32x32x16_bf16 v[64:79], v[16:19], v[168:171], v[64:79]
    v_mfma_f32_32x32x16_bf16 v[80:95], v[20:23], v[168:171], v[80:95]
    s_cmp_lg_u32 s62, 3
    s_cbranch_scc1 L_PD_4
    s_waitcnt vmcnt(3)
    v_cmp_ne_u32 vcc, s100, v113
    s_mov_b32 s76, 4000
    s_cbranch_vccz L_PD_4
L_PL_3:
    s_sleep 1
    buffer_load_dword v113, v112, s[12:15], 0 offen sc1
    s_waitcnt vmcnt(0)
    s_sub_u32 s76, s76, 1
    s_cmp_eq_u32 s76, 0
    s_cbranch_scc1 L_PD_4
    v_cmp_ne_u32 vcc, s100, v113
    s_cbranch_vccnz L_PL_3
L_PD_4:
    s_waitcnt vmcnt(8)
    s_barrier
    ds_read_b128 v[8:11], v4 offset:16384
    ds_read_b128 v[12:15], v4 offset:17408
    s_add_u32 m0, s69, 131072
    s_nop 0
    buffer_load_dwordx4 v2, s[12:15], s73 offen sc1 lds
    v_mfma_f32_32x32x16_bf16 v[64:79], v[24:27], v[172:175], v[64:79]
    v_bfe_u32 v48, v1, 2, 3
    v_lshlrev_b32 v48, 9, v48
    v_mfma_f32_32x32x16_bf16 v[80:95], v[28:31], v[172:175], v[80:95]
    s_add_u32 m0, s69, 131072
    s_nop 0
    buffer_load_dwordx4 v2, s[12:15], s73 offen offset:1024 sc1 lds
    s_add_u32 s74, s74, 1
    s_cmp_eq_u32 s74, 10
    s_mov_b32 s98, 16384
    s_cmov_b32 s98, -147456
    s_cselect_b32 s74, 0, s74
    s_add_u32 s73, s73, s98
    v_and_b32 v57, 3, v1
    v_lshl_add_u32 v48, v57, 6, v48
    ds_read_b128 v[16:19], v4 offset:20480
    ds_read_b128 v[20:23], v4 offset:21504
    ds_read_b128 v[24:27], v4 offset:24576
    ds_read_b128 v[28:31], v4 offset:25600
    s_waitcnt lgkmcnt(5)
    v_mfma_f32_32x32x16_bf16 v[64:79], v[8:11], v[176:179], v[64:79]
    v_bfe_u32 v57, v1, 2, 2
    v_lshrrev_b32 v58, 5, v1
    s_waitcnt lgkmcnt(4)
    v_mfma_f32_32x32x16_bf16 v[80:95], v[12:15], v[176:179], v[80:95]
    s_add_u32 s99, s18, 0
    s_add_u32 m0, s69, 0
    s_nop 0
    buffer_load_dwordx4 v2, s[12:15], s99 offen sc1 lds
    v_xor_b32 v57, v57, v58
    v_lshl_add_u32 v48, v57, 4, v48
    ds_read_b128 v[8:11], v4 offset:28672
    ds_read_b128 v[12:15], v4 offset:29696
    s_waitcnt lgkmcnt(5)
    v_mfma_f32_32x32x16_bf16 v[64:79], v[16:19], v[180:183], v[64:79]
    s_lshl_b32 s44, s68, 14
    s_lshl_b32 s45, s67, 12
    s_waitcnt lgkmcnt(4)
    v_mfma_f32_32x32x16_bf16 v[80:95], v[20:23], v[180:183], v[80:95]
    buffer_load_dwordx4 v2, s[12:15], s99 offen offset:1024 sc1 lds
    s_add_u32 s44, s44, s45
    s_add_u32 s44, s44, 131072
    s_waitcnt lgkmcnt(0)
    v_mfma_f32_32x32x16_bf16 v[64:79], v[24:27], v[184:187], v[64:79]
    v_add_u32 v48, s44, v48
    v_mfma_f32_32x32x16_bf16 v[80:95], v[28:31], v[184:187], v[80:95]
    v_xor_b32 v49, 32, v48
    s_waitcnt vmcnt(4)
    s_barrier
    s_lshl_b32 s40, s63, 4
    s_add_u32 s40, s40, s64
    s_lshl_b32 s40, s40, 7
    s_add_u32 s40, s40, 17956864
    s_cmp_eq_u32 s62, 0
    s_cselect_b32 s40, s40, s101
    v_mov_b32 v120, s100
    v_lshlrev_b32 v121, 2, v1
    s_cmp_eq_u32 s40, s101
    s_cselect_b32 exec_lo, 0, -1
    s_mov_b32 exec_hi, 0
    buffer_store_dword v120, v121, s[12:15], s40 offen sc1
    s_mov_b64 exec, -1
    ds_read_b128 v[16:19], v4 offset:32768
    ds_read_b128 v[20:23], v4 offset:33792
    s_mov_b64 exec, s[6:7]
    s_add_u32 m0, s69, 81920
    s_nop 0
    buffer_load_dwordx4 v2, s[12:15], s22 offen sc1 lds
    s_mov_b64 exec, -1
    s_mov_b64 exec, s[6:7]
    s_add_u32 m0, s69, 81920
    s_nop 0
    buffer_load_dwordx4 v2, s[12:15], s22 offen offset:1024 sc1 lds
    s_mov_b64 exec, -1
    v_mfma_f32_32x32x16_bf16 v[64:79], v[8:11], v[188:191], v[64:79]
    s_add_u32 m0, s69, 147456
    s_nop 0
    buffer_load_dwordx4 v2, s[12:15], s73 offen sc1 lds
    v_mul_u32_u24 v57, 24, v58
    v_mfma_f32_32x32x16_bf16 v[80:95], v[12:15], v[188:191], v[80:95]
    s_add_u32 m0, s69, 147456
    s_nop 0
    buffer_load_dwordx4 v2, s[12:15], s73 offen offset:1024 sc1 lds
    v_xor_b32 v50, v57, v48
    ds_read_b128 v[24:27], v4 offset:36864
    ds_read_b128 v[28:31], v4 offset:37888
    ds_read_b128 v[8:11], v4 offset:40960
    ds_read_b128 v[12:15], v4 offset:41984
    s_waitcnt lgkmcnt(5)
    v_mfma_f32_32x32x16_bf16 v[64:79], v[16:19], v[192:195], v[64:79]
    s_add_u32 s99, s18, 16384
    s_add_u32 m0, s69, 16384
    s_nop 0
    buffer_load_dwordx4 v2, s[12:15], s99 offen sc1 lds
    v_lshlrev_b32 v51, 2, v1
    s_waitcnt lgkmcnt(4)
    v_mfma_f32_32x32x16_bf16 v[80:95], v[20:23], v[192:195], v[80:95]
    buffer_load_dwordx4 v2, s[12:15], s99 offen offset:1024 sc1 lds
    v_add_u32 v51, -128, v51
    ds_read_b128 v[16:19], v4 offset:45056
    ds_read_b128 v[20:23], v4 offset:46080
    s_waitcnt lgkmcnt(5)
    v_mfma_f32_32x32x16_bf16 v[64:79], v[24:27], v[196:199], v[64:79]
    s_add_u32 s99, s18, 32768
    s_add_u32 m0, s69, 32768
    s_nop 0
    buffer_load_dwordx4 v2, s[12:15], s99 offen sc1 lds
    v_lshlrev_b32 v57, 10, v58
    s_waitcnt lgkmcnt(4)
    v_mfma_f32_32x32x16_bf16 v[80:95], v[28:31], v[196:199], v[80:95]
    buffer_load_dwordx4 v2, s[12:15], s99 offen offset:1024 sc1 lds
    v_bfe_u32 v59, v1, 2, 2
    s_waitcnt lgkmcnt(0)
    v_mfma_f32_32x32x16_bf16 v[64:79], v[8:11], v[200:203], v[64:79]
    v_lshl_add_u32 v57, v59, 6, v57
    v_and_b32 v59, 1, v1
    v_lshl_add_u32 v57, v59, 3, v57
    v_mfma_f32_32x32x16_bf16 v[80:95], v[12:15], v[200:203], v[80:95]
    v_bfe_u32 v59, v1, 4, 1
    v_bfe_u32 v60, v1, 1, 1
    v_lshl_add_u32 v59, v59, 1, v60
    s_barrier
    ds_read_b128 v[24:27], v4 offset:49152
    ds_read_b128 v[28:31], v4 offset:50176
    s_add_u32 s99, s18, 49152
    s_add_u32 m0, s69, 49152
    s_nop 0
    buffer_load_dwordx4 v2, s[12:15], s99 offen sc1 lds
    v_mfma_f32_32x32x16_bf16 v[64:79], v[16:19], v[204:207], v[64:79]
    v_add_u32 v60, 1, v59
    v_and_b32 v60, 3, v60
    v_lshlrev_b32 v56, 1, v58
    v_mfma_f32_32x32x16_bf16 v[80:95], v[20:23], v[204:207], v[80:95]
    buffer_load_dwordx4 v2, s[12:15], s99 offen offset:1024 sc1 lds
    v_xor_b32 v59, v59, v56
    v_xor_b32 v60, v60, v56
    v_lshl_add_u32 v59, v59, 4, v57
    ds_read_b128 v[8:11], v4 offset:53248
    ds_read_b128 v[12:15], v4 offset:54272
    ds_read_b128 v[16:19], v4 offset:57344
    ds_read_b128 v[20:23], v4 offset:58368
    s_waitcnt lgkmcnt(5)
    v_mfma_f32_32x32x16_bf16 v[64:79], v[24:27], v[208:211], v[64:79]
    v_lshl_add_u32 v60, v60, 4, v57
    s_bfe_u32 s44, s62, 0x10001
    s_lshl_b32 s46, s44, 14
    s_waitcnt lgkmcnt(4)
    v_mfma_f32_32x32x16_bf16 v[80:95], v[28:31], v[208:211], v[80:95]
    s_add_u32 s99, s18, 65536
    s_add_u32 m0, s69, 65536
    s_nop 0
    buffer_load_dwordx4 v2, s[12:15], s99 offen sc1 lds
    s_add_u32 s46, s46, 131072
    s_and_b32 s45, s62, 1
    s_lshl_b32 s47, s45, 8
    ds_read_b128 v[24:27], v4 offset:61440
    ds_read_b128 v[28:31], v4 offset:62464
    s_waitcnt lgkmcnt(5)
    v_mfma_f32_32x32x16_bf16 v[64:79], v[8:11], v[212:215], v[64:79]
    s_add_u32 s47, s47, s46
    v_add_u32 v52, s47, v59
    v_add_u32 v54, s46, v60
    s_waitcnt lgkmcnt(4)
    v_mfma_f32_32x32x16_bf16 v[80:95], v[12:15], v[212:215], v[80:95]
    buffer_load_dwordx4 v2, s[12:15], s99 offen offset:1024 sc1 lds
    s_lshl_b32 s60, s64, 4
    s_add_u32 s60, s60, s63
    s_mul_i32 s60, s60, 3584
    s_waitcnt lgkmcnt(0)
    v_mfma_f32_32x32x16_bf16 v[64:79], v[16:19], v[216:219], v[64:79]
    s_mul_i32 s47, s44, 1680
    s_add_u32 s60, s60, s47
    v_mfma_f32_32x32x16_bf16 v[80:95], v[20:23], v[216:219], v[80:95]
    s_mul_i32 s47, s45, 1344
    s_add_u32 s60, s60, s47
    s_waitcnt vmcnt(10)
    s_barrier
    s_and_b32 s31, s63, 11
    s_and_b32 s40, s2, 2
    s_lshl1_add_u32 s31, s40, s31
    s_lshl_b32 s31, s31, 11
    s_add_u32 s31, s31, 17956864
    v_and_b32 v122, 15, v1
    v_lshl_add_u32 v122, v122, 7, s31
    s_cmp_lg_u32 s62, 3
    s_cselect_b64 exec, 0, -1
    buffer_load_dword v123, v122, s[12:15], 0 offen sc1
    s_mov_b64 exec, -1
    ds_read_b128 v[8:11], v5 offset:0
    ds_read_b128 v[12:15], v5 offset:1024
    ds_read_b128 v[184:187], v0 offset:0
    ds_read_b128 v[188:191], v0 offset:1024
    ds_read_b128 v[192:195], v0 offset:2048
    s_add_u32 s99, s18, 98304
    s_add_u32 m0, s69, 98304
    s_nop 0
    buffer_load_dwordx4 v2, s[12:15], s99 offen sc1 lds
    v_mfma_f32_32x32x16_bf16 v[64:79], v[24:27], v[220:223], v[64:79]
    s_add_u32 s60, s60, 16777216
    v_and_b32 v57, 31, v1
    v_mfma_f32_32x32x16_bf16 v[80:95], v[28:31], v[220:223], v[80:95]
    buffer_load_dwordx4 v2, s[12:15], s99 offen offset:1024 sc1 lds
    v_mul_u32_u24 v58, 21, v58
    v_add_lshl_u32 v57, v57, v58, 4
    ds_read_b128 v[16:19], v5 offset:4096
    ds_read_b128 v[20:23], v5 offset:5120
    ds_read_b128 v[196:199], v0 offset:3072
    ds_read_b128 v[200:203], v0 offset:4096
    ds_read_b128 v[204:207], v0 offset:5120
    ds_read_b128 v[24:27], v5 offset:8192
    ds_read_b128 v[28:31], v5 offset:9216
    s_waitcnt lgkmcnt(11)
    v_mfma_f32_32x32x16_bf16 v[64:79], v[8:11], v[224:227], v[64:79]
    s_cmp_eq_u32 s45, 0
    s_cselect_b32 s61, s60, s101
    s_mov_b32 vcc_lo, 0x1fffff
    s_cselect_b32 vcc_hi, 0x1fffff, 0
    v_cndmask_b32_e64 v56, 2.0, v57, vcc
    s_waitcnt lgkmcnt(10)
    v_mfma_f32_32x32x16_bf16 v[80:95], v[12:15], v[224:227], v[80:95]
    v_xor_b32 v53, 16, v52
    v_xor_b32 v55, 16, v54
    ds_read_b128 v[8:11], v5 offset:12288
    ds_read_b128 v[12:15], v5 offset:13312
    s_waitcnt lgkmcnt(8)
    v_mfma_f32_32x32x16_bf16 v[64:79], v[16:19], v[228:231], v[64:79]
    s_waitcnt lgkmcnt(7)
    v_mfma_f32_32x32x16_bf16 v[80:95], v[20:23], v[228:231], v[80:95]
    s_waitcnt lgkmcnt(0)
    v_mfma_f32_32x32x16_bf16 v[64:79], v[24:27], v[232:235], v[64:79]
    v_mfma_f32_32x32x16_bf16 v[80:95], v[28:31], v[232:235], v[80:95]
    s_cmp_lg_u32 s62, 3
    s_cbranch_scc1 L_PD_6
    s_waitcnt vmcnt(2)
    v_cmp_ne_u32 vcc, s100, v123
    s_mov_b32 s76, 4000
    s_cbranch_vccz L_PD_6
L_PL_5:
    s_sleep 1
    buffer_load_dword v123, v122, s[12:15], 0 offen sc1
    s_waitcnt vmcnt(0)
    s_sub_u32 s76, s76, 1
    s_cmp_eq_u32 s76, 0
    s_cbranch_scc1 L_PD_6
    v_cmp_ne_u32 vcc, s100, v123
    s_cbranch_vccnz L_PL_5
L_PD_6:
    s_waitcnt vmcnt(11)
    s_barrier
    ds_read_b128 v[16:19], v5 offset:16384
    ds_read_b128 v[20:23], v5 offset:17408
    s_add_u32 s99, s18, 81920
    s_add_u32 m0, s69, 81920
    s_nop 0
    buffer_load_dwordx4 v2, s[12:15], s99 offen sc1 lds
    v_mfma_f32_32x32x16_bf16 v[64:79], v[8:11], v[236:239], v[64:79]
    v_mfma_f32_32x32x16_bf16 v[80:95], v[12:15], v[236:239], v[80:95]
    buffer_load_dwordx4 v2, s[12:15], s99 offen offset:1024 sc1 lds
    ds_read_b128 v[24:27], v5 offset:20480
    ds_read_b128 v[28:31], v5 offset:21504
    ds_read_b128 v[8:11], v5 offset:24576
    ds_read_b128 v[12:15], v5 offset:25600
    s_waitcnt lgkmcnt(5)
    v_mfma_f32_32x32x16_bf16 v[64:79], v[16:19], v[240:243], v[64:79]
    s_waitcnt lgkmcnt(4)
    v_mfma_f32_32x32x16_bf16 v[80:95], v[20:23], v[240:243], v[80:95]
    buffer_load_dwordx4 v[96:99], v2, s[12:15], s16 offen sc1
    ds_read_b128 v[16:19], v5 offset:28672
    ds_read_b128 v[20:23], v5 offset:29696
    s_waitcnt lgkmcnt(5)
    v_mfma_f32_32x32x16_bf16 v[64:79], v[24:27], v[244:247], v[64:79]
    s_waitcnt lgkmcnt(4)
    v_mfma_f32_32x32x16_bf16 v[80:95], v[28:31], v[244:247], v[80:95]
    buffer_load_dwordx4 v[100:103], v2, s[12:15], s17 offen sc1
    s_waitcnt lgkmcnt(0)
    v_mfma_f32_32x32x16_bf16 v[64:79], v[8:11], v[248:251], v[64:79]
    v_mfma_f32_32x32x16_bf16 v[80:95], v[12:15], v[248:251], v[80:95]
    s_waitcnt vmcnt(13)
    s_barrier
    v_mfma_f32_32x32x16_bf16 v[64:79], v[16:19], v[252:255], v[64:79]
    v_mfma_f32_32x32x16_bf16 v[80:95], v[20:23], v[252:255], v[80:95]
    s_xor_b32 s40, s79, 1
    s_mul_i32 s40, s40, 5120
    v_add_u32 v3, s40, v2
    v_add_u32 v4, 61440, v3
    s_sub_u32 s40, s16, s96
    s_sub_u32 s41, s17, s96
    v_add_u32 v0, s40, v2
    v_add_u32 v5, s41, v2
    s_cmp_ge_u32 s62, 4
    s_cbranch_scc1 L_OWN_7
    ds_read_b128 v[8:11], v3 offset:0
    ds_read_b128 v[12:15], v3 offset:1024
    ds_read_b128 v[16:19], v3 offset:2048
    ds_read_b128 v[20:23], v3 offset:3072
    ds_read_b128 v[24:27], v3 offset:4096
    ds_read_b128 v[28:31], v3 offset:10240
    ds_read_b128 v[32:35], v3 offset:11264
    ds_read_b128 v[36:39], v3 offset:12288
    ds_read_b128 v[40:43], v3 offset:13312
    ds_read_b128 v[44:47], v3 offset:14336
    v_cvt_pk_bf16_f32 v168, v64, v65
    v_cvt_pk_bf16_f32 v169, v66, v67
    v_cvt_pk_bf16_f32 v170, v68, v69
    v_cvt_pk_bf16_f32 v171, v70, v71
    v_cvt_pk_bf16_f32 v176, v72, v73
    v_cvt_pk_bf16_f32 v178, v88, v89
    s_add_u32 s99, s18, 114688
    s_add_u32 m0, s69, 114688
    s_mov_b64 exec, s[4:5]
    buffer_load_dwordx4 v2, s[12:15], s99 offen sc1 lds
    s_mov_b64 exec, -1
    v_cvt_pk_bf16_f32 v177, v74, v75
    v_cvt_pk_bf16_f32 v179, v90, v91
    v_mfma_f32_32x32x16_bf16 v[208:223], v[184:187], v[168:171], 0
    v_cvt_pk_bf16_f32 v180, v76, v77
    v_cvt_pk_bf16_f32 v181, v78, v79
    v_cvt_pk_bf16_f32 v182, v92, v93
    s_mov_b64 exec, s[4:5]
    buffer_load_dwordx4 v2, s[12:15], s99 offen offset:1024 sc1 lds
    s_mov_b64 exec, -1
    v_cvt_pk_bf16_f32 v183, v94, v95
    v_mfma_f32_32x32x16_bf16 v[208:223], v[188:191], v[176:179], v[208:223]
    v_cvt_pk_bf16_f32 v172, v80, v81
    v_cvt_pk_bf16_f32 v173, v82, v83
    v_cvt_pk_bf16_f32 v174, v84, v85
    v_cvt_pk_bf16_f32 v175, v86, v87
    buffer_load_dwordx4 v[104:107], v2, s[12:15], s16 offen offset:2048 sc1
    v_mul_f32 v6, s20, v92
    v_mov_b32 v61, 0x3f80
    v_mfma_f32_32x32x16_bf16 v[64:79], v[196:199], v[168:171], 0
    s_mov_b32 vcc_lo, 0
    s_mov_b32 vcc_hi, -1
    v_cndmask_b32_e32 v182, v182, v61, vcc
    v_cndmask_b32_e64 v183, v183, 0, vcc
    v_cndmask_b32_e64 v51, 2.0, v51, vcc
    v_mfma_f32_32x32x16_bf16 v[64:79], v[204:207], v[176:179], v[64:79]
    ds_write_b128 v48, v[176:179] offset:256
    buffer_load_dwordx4 v[108:111], v2, s[12:15], s17 offen offset:2048 sc1
    v_mfma_f32_32x32x16_bf16 v[64:79], v[200:203], v[172:175], v[64:79]
    ds_write_b128 v49, v[180:183] offset:256
    v_mfma_f32_32x32x16_bf16 v[80:95], v[184:187], v[172:175], 0
    v_mfma_f32_32x32x16_bf16 v[80:95], v[192:195], v[176:179], v[80:95]
    v_max3_f32 v58, v208, v209, v210
    v_max3_f32 v59, v211, v212, v213
    s_add_u32 s96, s96, 4096
    buffer_load_dwordx4 v[112:115], v0, s[12:15], s96 offen sc1
    v_max3_f32 v58, v58, v214, v215
    v_max3_f32 v59, v59, v216, v217
    v_max3_f32 v58, v58, v218, v219
    v_max3_f32 v59, v59, v220, v221
    v_max3_f32 v58, v58, v222, v223
    v_max3_f32 v59, v59, v64, v65
    buffer_load_dwordx4 v[116:119], v5, s[12:15], s96 offen sc1
    v_max3_f32 v58, v58, v66, v67
    v_max_f32 v58, v58, v59
    v_mul_f32 v58, s32, v58
    v_pk_fma_f32 v[208:209], v[208:209], s[20:21], v[58:59] op_sel_hi:[1,1,0]
    v_pk_fma_f32 v[210:211], v[210:211], s[20:21], v[58:59] op_sel_hi:[1,1,0]
    v_exp_f32 v208, v208
    s_waitcnt vmcnt(12)
    buffer_load_dwordx4 v[120:123], v0, s[12:15], s96 offen offset:2048 sc1
    v_exp_f32 v209, v209
    v_pk_fma_f32 v[212:213], v[212:213], s[20:21], v[58:59] op_sel_hi:[1,1,0]
    v_exp_f32 v210, v210
    v_exp_f32 v211, v211
    v_pk_fma_f32 v[214:215], v[214:215], s[20:21], v[58:59] op_sel_hi:[1,1,0]
    v_exp_f32 v212, v212
    buffer_load_dwordx4 v[124:127], v5, s[12:15], s96 offen offset:2048 sc1
    v_exp_f32 v213, v213
    v_pk_add_f32 v[60:61], v[208:209], v[210:211]
    v_pk_fma_f32 v[216:217], v[216:217], s[20:21], v[58:59] op_sel_hi:[1,1,0]
    v_exp_f32 v214, v214
    v_exp_f32 v215, v215
    v_pk_add_f32 v[60:61], v[60:61], v[212:213]
    s_add_u32 s96, s96, 4096
    buffer_load_dwordx4 v[128:131], v0, s[12:15], s96 offen sc1
    v_pk_fma_f32 v[218:219], v[218:219], s[20:21], v[58:59] op_sel_hi:[1,1,0]
    v_exp_f32 v216, v216
    v_exp_f32 v217, v217
    v_pk_add_f32 v[60:61], v[60:61], v[214:215]
    v_pk_fma_f32 v[220:221], v[220:221], s[20:21], v[58:59] op_sel_hi:[1,1,0]
    v_exp_f32 v218, v218
    buffer_load_dwordx4 v[132:135], v5, s[12:15], s96 offen sc1
    v_exp_f32 v219, v219
    v_pk_add_f32 v[60:61], v[60:61], v[216:217]
    v_pk_fma_f32 v[222:223], v[222:223], s[20:21], v[58:59] op_sel_hi:[1,1,0]
    v_exp_f32 v220, v220
    v_exp_f32 v221, v221
    v_pk_add_f32 v[60:61], v[60:61], v[218:219]
    buffer_load_dwordx4 v[136:139], v0, s[12:15], s96 offen offset:2048 sc1
    v_pk_fma_f32 v[64:65], v[64:65], s[20:21], v[58:59] op_sel_hi:[1,1,0]
    v_exp_f32 v222, v222
    v_exp_f32 v223, v223
    v_pk_add_f32 v[60:61], v[60:61], v[220:221]
    v_pk_fma_f32 v[66:67], v[66:67], s[20:21], v[58:59] op_sel_hi:[1,1,0]
    v_exp_f32 v64, v64
    buffer_load_dwordx4 v[140:143], v5, s[12:15], s96 offen offset:2048 sc1
    v_exp_f32 v65, v65
    v_pk_add_f32 v[60:61], v[60:61], v[222:223]
    v_exp_f32 v66, v66
    v_exp_f32 v67, v67
    v_pk_add_f32 v[60:61], v[60:61], v[64:65]
    v_pk_add_f32 v[60:61], v[60:61], v[66:67]
    s_add_u32 s96, s96, 4096
    buffer_load_dwordx4 v[144:147], v0, s[12:15], s96 offen sc1
    v_add_f32 v60, v60, v61
    v_rcp_f32 v60, v60
    s_nop 0
    v_pk_mul_f32 v[208:209], v[208:209], v[60:61] op_sel_hi:[1,0]
    v_pk_mul_f32 v[210:211], v[210:211], v[60:61] op_sel_hi:[1,0]
    v_pk_mul_f32 v[212:213], v[212:213], v[60:61] op_sel_hi:[1,0]
    v_pk_mul_f32 v[214:215], v[214:215], v[60:61] op_sel_hi:[1,0]
    buffer_load_dwordx4 v[148:151], v5, s[12:15], s96 offen sc1
    v_cvt_pk_bf16_f32 v184, v208, v209
    v_cvt_pk_bf16_f32 v185, v210, v211
    v_cvt_pk_bf16_f32 v186, v212, v213
    v_cvt_pk_bf16_f32 v187, v214, v215
    ds_write_b128 v48, v[184:187]
    v_pk_mul_f32 v[216:217], v[216:217], v[60:61] op_sel_hi:[1,0]
    buffer_load_dwordx4 v[152:155], v0, s[12:15], s96 offen offset:2048 sc1
    v_pk_mul_f32 v[218:219], v[218:219], v[60:61] op_sel_hi:[1,0]
    v_pk_mul_f32 v[220:221], v[220:221], v[60:61] op_sel_hi:[1,0]
    v_pk_mul_f32 v[222:223], v[222:223], v[60:61] op_sel_hi:[1,0]
    v_cvt_pk_bf16_f32 v188, v216, v217
    v_cvt_pk_bf16_f32 v189, v218, v219
    v_cvt_pk_bf16_f32 v190, v220, v221
    buffer_load_dwordx4 v[156:159], v5, s[12:15], s96 offen offset:2048 sc1
    v_cvt_pk_bf16_f32 v191, v222, v223
    ds_write_b128 v49, v[188:191]
    v_pk_mul_f32 v[64:65], v[64:65], v[60:61] op_sel_hi:[1,0]
    v_pk_mul_f32 v[66:67], v[66:67], v[60:61] op_sel_hi:[1,0]
    v_cvt_pk_bf16_f32 v192, v64, v65
    v_cvt_pk_bf16_f32 v193, v66, v67
    ds_write_b64 v50, v[192:193] offset:256
    s_waitcnt vmcnt(18)
    s_waitcnt lgkmcnt(0)
    s_barrier
    s_waitcnt vmcnt(16)
    v_mfma_f32_16x16x32_bf16 v[208:211], v[8:11], v[96:99], 0
    v_min_f32 v6, 0x42700000, v6
    v_exp_f32 v6, v6
    v_mfma_f32_16x16x32_bf16 v[212:215], v[12:15], v[96:99], 0
    s_add_u32 s99, s18, 122880
    s_add_u32 m0, s69, 0
    s_nop 0
    buffer_load_dwordx4 v2, s[12:15], s99 offen sc1 lds
    v_mov_b32 v62, v6
    s_nop 1
    v_permlane32_swap_b32 v62, v6
    v_mfma_f32_16x16x32_bf16 v[216:219], v[16:19], v[96:99], 0
    v_max3_f32 v58, v80, v81, v82
    v_max3_f32 v59, v83, v84, v85
    v_max3_f32 v58, v58, v86, v87
    v_mfma_f32_16x16x32_bf16 v[220:223], v[20:23], v[96:99], 0
    buffer_load_dwordx4 v2, s[12:15], s99 offen offset:1024 sc1 lds
    v_max3_f32 v59, v59, v88, v89
    v_max3_f32 v58, v58, v90, v91
    v_mfma_f32_16x16x32_bf16 v[224:227], v[24:27], v[96:99], 0
    v_max3_f32 v59, v59, v92, v93
    v_max3_f32 v58, v58, v94, v95
    v_max3_f32 v59, v59, v68, v69
    v_mfma_f32_16x16x32_bf16 v[228:231], v[8:11], v[100:103], 0
    s_add_u32 s96, s96, 4096
    buffer_load_dwordx4 v[160:163], v0, s[12:15], s96 offen sc1
    v_max3_f32 v58, v58, v70, v71
    v_max_f32 v58, v58, v59
    v_mfma_f32_16x16x32_bf16 v[232:235], v[12:15], v[100:103], 0
    v_mul_f32 v58, s32, v58
    v_fma_f32 v80, v80, s20, v58
    v_fma_f32 v81, v81, s20, v58
    v_mfma_f32_16x16x32_bf16 v[236:239], v[16:19], v[100:103], 0
    buffer_load_dwordx4 v[164:167], v5, s[12:15], s96 offen sc1
    v_fma_f32 v82, v82, s20, v58
    v_fma_f32 v83, v83, s20, v58
    v_mfma_f32_16x16x32_bf16 v[240:243], v[20:23], v[100:103], 0
    v_exp_f32 v80, v80
    v_exp_f32 v81, v81
    v_fma_f32 v84, v84, s20, v58
    v_mfma_f32_16x16x32_bf16 v[244:247], v[24:27], v[100:103], 0
    buffer_load_dwordx4 v[168:171], v0, s[12:15], s96 offen offset:2048 sc1
    v_fma_f32 v85, v85, s20, v58
    v_exp_f32 v82, v82
    s_barrier
    s_waitcnt vmcnt(17)
    v_mfma_f32_16x16x32_bf16 v[208:211], v[28:31], v[104:107], v[208:211]
    ds_read_b128 v[8:11], v3 offset:20480
    v_exp_f32 v83, v83
    v_fma_f32 v86, v86, s20, v58
    v_mfma_f32_16x16x32_bf16 v[212:215], v[32:35], v[104:107], v[212:215]
    ds_read_b128 v[12:15], v3 offset:21504
    buffer_load_dwordx4 v[172:175], v5, s[12:15], s96 offen offset:2048 sc1
    v_fma_f32 v87, v87, s20, v58
    v_mfma_f32_16x16x32_bf16 v[216:219], v[36:39], v[104:107], v[216:219]
    ds_read_b128 v[16:19], v3 offset:22528
    v_exp_f32 v84, v84
    v_exp_f32 v85, v85
    v_mfma_f32_16x16x32_bf16 v[220:223], v[40:43], v[104:107], v[220:223]
    ds_read_b128 v[20:23], v3 offset:23552
    s_add_u32 s96, s96, 4096
    buffer_load_dwordx4 v[176:179], v0, s[12:15], s96 offen sc1
    v_add_f32 v60, v80, v82
    v_mfma_f32_16x16x32_bf16 v[224:227], v[44:47], v[104:107], v[224:227]
    ds_read_b128 v[24:27], v3 offset:24576
    v_add_f32 v61, v81, v83
    v_fma_f32 v88, v88, s20, v58
    v_mfma_f32_16x16x32_bf16 v[228:231], v[28:31], v[108:111], v[228:231]
    buffer_load_dwordx4 v[180:183], v5, s[12:15], s96 offen sc1
    v_fma_f32 v89, v89, s20, v58
    v_exp_f32 v86, v86
    v_mfma_f32_16x16x32_bf16 v[232:235], v[32:35], v[108:111], v[232:235]
    v_exp_f32 v87, v87
    v_add_f32 v60, v60, v84
    v_add_f32 v61, v61, v85
    v_mfma_f32_16x16x32_bf16 v[236:239], v[36:39], v[108:111], v[236:239]
    buffer_load_dwordx4 v[184:187], v0, s[12:15], s96 offen offset:2048 sc1
    v_fma_f32 v90, v90, s20, v58
    v_fma_f32 v91, v91, s20, v58
    v_mfma_f32_16x16x32_bf16 v[240:243], v[40:43], v[108:111], v[240:243]
    v_exp_f32 v88, v88
    v_exp_f32 v89, v89
    v_add_f32 v60, v60, v86
    v_mfma_f32_16x16x32_bf16 v[244:247], v[44:47], v[108:111], v[244:247]
    buffer_load_dwordx4 v[188:191], v5, s[12:15], s96 offen offset:2048 sc1
    v_add_f32 v61, v61, v87
    v_fma_f32 v92, v92, s20, v58
    s_waitcnt lgkmcnt(0)
    s_waitcnt vmcnt(20)
    v_mfma_f32_16x16x32_bf16 v[208:211], v[8:11], v[112:115], v[208:211]
    ds_read_b128 v[28:31], v3 offset:30720
    v_fma_f32 v93, v93, s20, v58
    v_exp_f32 v90, v90
    v_mfma_f32_16x16x32_bf16 v[212:215], v[12:15], v[112:115], v[212:215]
    ds_read_b128 v[32:35], v3 offset:31744
    s_add_u32 s96, s96, 4096
    s_mov_b64 exec, s[8:9]
    buffer_load_dwordx4 v[200:203], v0, s[12:15], s96 offen offset:2048 sc1
    buffer_load_dwordx4 v[204:207], v5, s[12:15], s96 offen offset:2048 sc1
    s_mov_b64 exec, -1
    v_exp_f32 v91, v91
    v_mfma_f32_16x16x32_bf16 v[216:219], v[16:19], v[112:115], v[216:219]
    ds_read_b128 v[36:39], v3 offset:32768
    v_add_f32 v60, v60, v88
    v_add_f32 v61, v61, v89
    v_mfma_f32_16x16x32_bf16 v[220:223], v[20:23], v[112:115], v[220:223]
    ds_read_b128 v[40:43], v3 offset:33792
    buffer_load_dwordx4 v[192:195], v0, s[12:15], s96 offen sc1
    v_fma_f32 v94, v94, s20, v58
    v_mfma_f32_16x16x32_bf16 v[224:227], v[24:27], v[112:115], v[224:227]
    ds_read_b128 v[44:47], v3 offset:34816
    v_fma_f32 v95, v95, s20, v58
    v_exp_f32 v92, v92
    v_mfma_f32_16x16x32_bf16 v[228:231], v[8:11], v[116:119], v[228:231]
    buffer_load_dwordx4 v[196:199], v5, s[12:15], s96 offen sc1
    v_exp_f32 v93, v93
    v_add_f32 v60, v60, v90
    v_mfma_f32_16x16x32_bf16 v[232:235], v[12:15], v[116:119], v[232:235]
    v_add_f32 v61, v61, v91
    v_fma_f32 v68, v68, s20, v58
    v_fma_f32 v69, v69, s20, v58
    v_mfma_f32_16x16x32_bf16 v[236:239], v[16:19], v[116:119], v[236:239]
    v_exp_f32 v94, v94
    v_exp_f32 v95, v95
    v_add_f32 v60, v60, v92
    v_mfma_f32_16x16x32_bf16 v[240:243], v[20:23], v[116:119], v[240:243]
    v_add_f32 v61, v61, v93
    v_fma_f32 v70, v70, s20, v58
    v_fma_f32 v71, v71, s20, v58
    v_mfma_f32_16x16x32_bf16 v[244:247], v[24:27], v[116:119], v[244:247]
    v_exp_f32 v68, v68
    v_exp_f32 v69, v69
    v_add_f32 v60, v60, v94
    s_waitcnt lgkmcnt(0)
    s_waitcnt vmcnt(22)
    v_mfma_f32_16x16x32_bf16 v[208:211], v[28:31], v[120:123], v[208:211]
    ds_read_b128 v[8:11], v3 offset:40960
    v_add_f32 v61, v61, v95
    v_exp_f32 v70, v70
    v_mfma_f32_16x16x32_bf16 v[212:215], v[32:35], v[120:123], v[212:215]
    ds_read_b128 v[12:15], v3 offset:41984
    v_exp_f32 v71, v71
    v_add_f32 v60, v60, v68
    v_mfma_f32_16x16x32_bf16 v[216:219], v[36:39], v[120:123], v[216:219]
    ds_read_b128 v[16:19], v3 offset:43008
    v_add_f32 v61, v61, v69
    v_add_f32 v60, v60, v70
    v_mfma_f32_16x16x32_bf16 v[220:223], v[40:43], v[120:123], v[220:223]
    ds_read_b128 v[20:23], v3 offset:44032
    v_add_f32 v61, v61, v71
    v_add_f32 v60, v60, v61
    v_mfma_f32_16x16x32_bf16 v[224:227], v[44:47], v[120:123], v[224:227]
    ds_read_b128 v[24:27], v3 offset:45056
    v_rcp_f32 v60, v60
    s_nop 0
    v_mul_f32 v80, v80, v60
    v_mfma_f32_16x16x32_bf16 v[228:231], v[28:31], v[124:127], v[228:231]
    v_mul_f32 v81, v81, v60
    v_mul_f32 v82, v82, v60
    v_mul_f32 v83, v83, v60
    v_mfma_f32_16x16x32_bf16 v[232:235], v[32:35], v[124:127], v[232:235]
    v_mul_f32 v84, v84, v60
    v_mul_f32 v85, v85, v60
    v_mul_f32 v86, v86, v60
    v_mfma_f32_16x16x32_bf16 v[236:239], v[36:39], v[124:127], v[236:239]
    v_mul_f32 v87, v87, v60
    v_cvt_pk_bf16_f32 v72, v80, v81
    v_cvt_pk_bf16_f32 v73, v82, v83
    v_mfma_f32_16x16x32_bf16 v[240:243], v[40:43], v[124:127], v[240:243]
    v_cvt_pk_bf16_f32 v74, v84, v85
    v_cvt_pk_bf16_f32 v75, v86, v87
    v_mul_f32 v88, v88, v60
    v_mfma_f32_16x16x32_bf16 v[244:247], v[44:47], v[124:127], v[244:247]
    v_mul_f32 v89, v89, v60
    v_mul_f32 v90, v90, v60
    v_mul_f32 v91, v91, v60
    s_waitcnt lgkmcnt(0)
    s_waitcnt vmcnt(20)
    v_mfma_f32_16x16x32_bf16 v[208:211], v[8:11], v[128:131], v[208:211]
    ds_read_b128 v[28:31], v3 offset:51200
    v_mul_f32 v92, v92, v60
    v_mul_f32 v93, v93, v60
    v_mfma_f32_16x16x32_bf16 v[212:215], v[12:15], v[128:131], v[212:215]
    ds_read_b128 v[32:35], v3 offset:52224
    v_mul_f32 v94, v94, v60
    v_mul_f32 v95, v95, v60
    v_mfma_f32_16x16x32_bf16 v[216:219], v[16:19], v[128:131], v[216:219]
    ds_read_b128 v[36:39], v3 offset:53248
    v_cvt_pk_bf16_f32 v76, v88, v89
    v_cvt_pk_bf16_f32 v77, v90, v91
    v_mfma_f32_16x16x32_bf16 v[220:223], v[20:23], v[128:131], v[220:223]
    ds_read_b128 v[40:43], v3 offset:54272
    v_cvt_pk_bf16_f32 v78, v92, v93
    v_cvt_pk_bf16_f32 v79, v94, v95
    v_mfma_f32_16x16x32_bf16 v[224:227], v[24:27], v[128:131], v[224:227]
    ds_read_b128 v[44:47], v3 offset:55296
    v_mul_f32 v68, v68, v60
    v_mul_f32 v69, v69, v60
    v_mfma_f32_16x16x32_bf16 v[228:231], v[8:11], v[132:135], v[228:231]
    v_mul_f32 v70, v70, v60
    v_mul_f32 v71, v71, v60
    v_cvt_pk_bf16_f32 v64, v68, v69
    v_mfma_f32_16x16x32_bf16 v[232:235], v[12:15], v[132:135], v[232:235]
    v_cvt_pk_bf16_f32 v65, v70, v71
    s_mov_b32 vcc_lo, 0
    s_mov_b32 vcc_hi, -1
    v_cndmask_b32_e32 v66, 0, v64, vcc
    v_cndmask_b32_e32 v67, 0, v65, vcc
    v_cndmask_b32_e64 v64, v64, 0, vcc
    v_cndmask_b32_e64 v65, v65, 0, vcc
    v_bfe_u32 v60, v1, 3, 1
    v_mfma_f32_16x16x32_bf16 v[236:239], v[16:19], v[132:135], v[236:239]
    v_and_b32 v61, 3, v1
    v_lshl_add_u32 v60, v60, 2, v61
    v_and_b32 v61, 16, v1
    v_mfma_f32_16x16x32_bf16 v[240:243], v[20:23], v[132:135], v[240:243]
    v_add_u32 v60, v60, v61
    v_bfe_u32 v61, v1, 2, 1
    v_lshl_add_u32 v60, v61, 3, v60
    v_mfma_f32_16x16x32_bf16 v[244:247], v[24:27], v[132:135], v[244:247]
    v_min_u32 v60, 20, v60
    v_lshlrev_b32 v60, 4, v60
    s_mul_i32 s40, s68, 1680
    s_add_u32 s40, s40, 16384
    v_add_u32 v54, s40, v60
    s_waitcnt lgkmcnt(0)
    s_waitcnt vmcnt(18)
    v_mfma_f32_16x16x32_bf16 v[208:211], v[28:31], v[136:139], v[208:211]
    ds_read_b128 v[8:11], v4 offset:0
    v_lshrrev_b32 v61, 5, v1
    v_mul_u32_u24 v61, 336, v61
    v_mfma_f32_16x16x32_bf16 v[212:215], v[32:35], v[136:139], v[212:215]
    ds_read_b128 v[12:15], v4 offset:1024
    v_add_u32 v55, v54, v61
    v_mfma_f32_16x16x32_bf16 v[216:219], v[36:39], v[136:139], v[216:219]
    ds_read_b128 v[16:19], v4 offset:2048
    v_mfma_f32_16x16x32_bf16 v[220:223], v[40:43], v[136:139], v[220:223]
    ds_read_b128 v[20:23], v4 offset:3072
    v_mfma_f32_16x16x32_bf16 v[224:227], v[44:47], v[136:139], v[224:227]
    ds_read_b128 v[24:27], v4 offset:4096
    v_mfma_f32_16x16x32_bf16 v[228:231], v[28:31], v[140:143], v[228:231]
    v_mfma_f32_16x16x32_bf16 v[232:235], v[32:35], v[140:143], v[232:235]
    v_mfma_f32_16x16x32_bf16 v[236:239], v[36:39], v[140:143], v[236:239]
    v_mfma_f32_16x16x32_bf16 v[240:243], v[40:43], v[140:143], v[240:243]
    v_mfma_f32_16x16x32_bf16 v[244:247], v[44:47], v[140:143], v[244:247]
    s_waitcnt lgkmcnt(0)
    s_waitcnt vmcnt(16)
    v_mfma_f32_16x16x32_bf16 v[208:211], v[8:11], v[144:147], v[208:211]
    ds_read_b128 v[28:31], v4 offset:10240
    v_mfma_f32_16x16x32_bf16 v[212:215], v[12:15], v[144:147], v[212:215]
    ds_read_b128 v[32:35], v4 offset:11264
    v_mfma_f32_16x16x32_bf16 v[216:219], v[16:19], v[144:147], v[216:219]
    ds_read_b128 v[36:39], v4 offset:12288
    v_mfma_f32_16x16x32_bf16 v[220:223], v[20:23], v[144:147], v[220:223]
    ds_read_b128 v[40:43], v4 offset:13312
    v_mfma_f32_16x16x32_bf16 v[224:227], v[24:27], v[144:147], v[224:227]
    ds_read_b128 v[44:47], v4 offset:14336
    v_mfma_f32_16x16x32_bf16 v[228:231], v[8:11], v[148:151], v[228:231]
    v_mfma_f32_16x16x32_bf16 v[232:235], v[12:15], v[148:151], v[232:235]
    v_mfma_f32_16x16x32_bf16 v[236:239], v[16:19], v[148:151], v[236:239]
    v_mfma_f32_16x16x32_bf16 v[240:243], v[20:23], v[148:151], v[240:243]
    v_mfma_f32_16x16x32_bf16 v[244:247], v[24:27], v[148:151], v[244:247]
    s_waitcnt lgkmcnt(0)
    s_waitcnt vmcnt(14)
    v_mfma_f32_16x16x32_bf16 v[208:211], v[28:31], v[152:155], v[208:211]
    ds_read_b128 v[8:11], v4 offset:20480
    v_mfma_f32_16x16x32_bf16 v[212:215], v[32:35], v[152:155], v[212:215]
    ds_read_b128 v[12:15], v4 offset:21504
    s_mul_i32 s46, s67, 10240
    s_add_u32 s96, s46, s19
    s_add_u32 m0, s46, 122880
    s_add_u32 s47, s96, 0
    buffer_load_dwordx4 v2, s[12:15], s47 offen sc1 lds
    v_mfma_f32_16x16x32_bf16 v[216:219], v[36:39], v[152:155], v[216:219]
    ds_read_b128 v[16:19], v4 offset:22528
    v_mfma_f32_16x16x32_bf16 v[220:223], v[40:43], v[152:155], v[220:223]
    ds_read_b128 v[20:23], v4 offset:23552
    buffer_load_dwordx4 v2, s[12:15], s47 offen offset:1024 sc1 lds
    v_mfma_f32_16x16x32_bf16 v[224:227], v[44:47], v[152:155], v[224:227]
    ds_read_b128 v[24:27], v4 offset:24576
    v_mfma_f32_16x16x32_bf16 v[228:231], v[28:31], v[156:159], v[228:231]
    buffer_load_dwordx4 v2, s[12:15], s47 offen offset:2048 sc1 lds
    v_mfma_f32_16x16x32_bf16 v[232:235], v[32:35], v[156:159], v[232:235]
    v_mfma_f32_16x16x32_bf16 v[236:239], v[36:39], v[156:159], v[236:239]
    buffer_load_dwordx4 v2, s[12:15], s47 offen offset:3072 sc1 lds
    v_mfma_f32_16x16x32_bf16 v[240:243], v[40:43], v[156:159], v[240:243]
    v_mfma_f32_16x16x32_bf16 v[244:247], v[44:47], v[156:159], v[244:247]
    s_add_u32 m0, s46, 126976
    s_add_u32 s47, s96, 4096
    buffer_load_dwordx4 v2, s[12:15], s47 offen sc1 lds
    s_waitcnt lgkmcnt(0)
    s_waitcnt vmcnt(15)
    v_mfma_f32_16x16x32_bf16 v[208:211], v[8:11], v[160:163], v[208:211]
    ds_read_b128 v[28:31], v4 offset:30720
    v_mfma_f32_16x16x32_bf16 v[212:215], v[12:15], v[160:163], v[212:215]
    ds_read_b128 v[32:35], v4 offset:31744
    buffer_load_dwordx4 v2, s[12:15], s47 offen offset:1024 sc1 lds
    v_mfma_f32_16x16x32_bf16 v[216:219], v[16:19], v[160:163], v[216:219]
    ds_read_b128 v[36:39], v4 offset:32768
    v_mfma_f32_16x16x32_bf16 v[220:223], v[20:23], v[160:163], v[220:223]
    ds_read_b128 v[40:43], v4 offset:33792
    buffer_load_dwordx4 v2, s[12:15], s47 offen offset:2048 sc1 lds
    v_mfma_f32_16x16x32_bf16 v[224:227], v[24:27], v[160:163], v[224:227]
    ds_read_b128 v[44:47], v4 offset:34816
    v_mfma_f32_16x16x32_bf16 v[228:231], v[8:11], v[164:167], v[228:231]
    buffer_load_dwordx4 v2, s[12:15], s47 offen offset:3072 sc1 lds
    v_mfma_f32_16x16x32_bf16 v[232:235], v[12:15], v[164:167], v[232:235]
    v_mfma_f32_16x16x32_bf16 v[236:239], v[16:19], v[164:167], v[236:239]
    s_add_u32 m0, s46, 131072
    s_add_u32 s47, s96, 8192
    buffer_load_dwordx4 v2, s[12:15], s47 offen sc1 lds
    v_mfma_f32_16x16x32_bf16 v[240:243], v[20:23], v[164:167], v[240:243]
    v_mfma_f32_16x16x32_bf16 v[244:247], v[24:27], v[164:167], v[244:247]
    buffer_load_dwordx4 v2, s[12:15], s47 offen offset:1024 sc1 lds
    s_waitcnt lgkmcnt(0)
    s_barrier
    s_setprio 1
    ds_read_b128 v[80:83], v55 offset:0
    ds_read_b128 v[84:87], v55 offset:672
    ds_read_b128 v[88:91], v54 offset:1344
    s_lshl_b32 s45, s68, 9
    s_add_u32 s45, s45, s29
    s_lshl3_add_u32 s44, s68, s29
    s_waitcnt lgkmcnt(2)
    v_mfma_f32_32x32x16_bf16 v[96:111], v[80:83], v[72:75], 0
    s_waitcnt lgkmcnt(1)
    v_mfma_f32_32x32x16_bf16 v[96:111], v[84:87], v[76:79], v[96:111]
    s_waitcnt lgkmcnt(0)
    v_mfma_f32_32x32x16_bf16 v[96:111], v[88:91], v[64:67], v[96:111]
    s_nop 7
    s_nop 3
    v_add_f32 v92, 0x358637bd, v108
    v_rcp_f32 v92, v92
    s_nop 0
    v_mul_f32 v92, v92, v6
    v_mul_f32 v96, v96, v92
    v_mul_f32 v97, v97, v92
    v_mul_f32 v98, v98, v92
    v_mul_f32 v99, v99, v92
    v_mul_f32 v100, v100, v92
    v_mul_f32 v101, v101, v92
    v_mul_f32 v102, v102, v92
    v_mul_f32 v103, v103, v92
    v_mul_f32 v104, v104, v92
    v_mul_f32 v105, v105, v92
    v_mul_f32 v106, v106, v92
    v_mul_f32 v107, v107, v92
    v_cvt_pk_bf16_f32 v48, v96, v97
    v_cvt_pk_bf16_f32 v49, v98, v99
    v_cvt_pk_bf16_f32 v50, v100, v101
    v_cvt_pk_bf16_f32 v51, v102, v103
    v_cvt_pk_bf16_f32 v52, v104, v105
    v_cvt_pk_bf16_f32 v53, v106, v107
    buffer_store_dwordx4 v[48:51], v7, s[12:15], s45 offen sc1
    s_mov_b32 exec_hi, 0
    buffer_store_dwordx2 v[52:53], v7, s[12:15], s44 offen offset:1024 sc1
    s_mov_b32 exec_hi, -1
    s_setprio 0
    ds_read_b128 v[8:11], v4 offset:40960
    ds_read_b128 v[12:15], v4 offset:41984
    ds_read_b128 v[16:19], v4 offset:43008
    ds_read_b128 v[20:23], v4 offset:44032
    ds_read_b128 v[24:27], v4 offset:45056
    s_waitcnt vmcnt(20)
    v_mfma_f32_16x16x32_bf16 v[208:211], v[28:31], v[168:171], v[208:211]
    ds_read_b128 v[64:67], v4 offset:51200
    s_mul_i32 s40, s67, 5120
    s_add_u32 s40, s40, 61440
    v_add_u32 v55, s40, v2
    v_mfma_f32_16x16x32_bf16 v[212:215], v[32:35], v[168:171], v[212:215]
    ds_read_b128 v[68:71], v4 offset:52224
    s_mul_i32 s40, s67, 5120
    s_mul_i32 s41, s79, -20480
    s_add_u32 s40, s40, s41
    s_add_u32 s40, s40, 71680
    v_add_u32 v56, s40, v2
    v_mfma_f32_16x16x32_bf16 v[216:219], v[36:39], v[168:171], v[216:219]
    ds_read_b128 v[72:75], v4 offset:53248
    v_mov_b32 v54, s100
    v_mfma_f32_16x16x32_bf16 v[220:223], v[40:43], v[168:171], v[220:223]
    ds_read_b128 v[76:79], v4 offset:54272
    v_mfma_f32_16x16x32_bf16 v[224:227], v[44:47], v[168:171], v[224:227]
    ds_read_b128 v[80:83], v4 offset:55296
    v_mfma_f32_16x16x32_bf16 v[228:231], v[28:31], v[172:175], v[228:231]
    v_mfma_f32_16x16x32_bf16 v[232:235], v[32:35], v[172:175], v[232:235]
    v_mfma_f32_16x16x32_bf16 v[236:239], v[36:39], v[172:175], v[236:239]
    v_mfma_f32_16x16x32_bf16 v[240:243], v[40:43], v[172:175], v[240:243]
    v_mfma_f32_16x16x32_bf16 v[244:247], v[44:47], v[172:175], v[244:247]
    s_waitcnt lgkmcnt(5)
    s_waitcnt vmcnt(18)
    v_mfma_f32_16x16x32_bf16 v[208:211], v[8:11], v[176:179], v[208:211]
    ds_read_b128 v[28:31], v3 offset:10240
    v_mfma_f32_16x16x32_bf16 v[212:215], v[12:15], v[176:179], v[212:215]
    ds_read_b128 v[32:35], v3 offset:11264
    v_mfma_f32_16x16x32_bf16 v[216:219], v[16:19], v[176:179], v[216:219]
    ds_read_b128 v[36:39], v3 offset:12288
    v_mfma_f32_16x16x32_bf16 v[220:223], v[20:23], v[176:179], v[220:223]
    ds_read_b128 v[40:43], v3 offset:13312
    v_mfma_f32_16x16x32_bf16 v[224:227], v[24:27], v[176:179], v[224:227]
    ds_read_b128 v[44:47], v3 offset:14336
    v_mfma_f32_16x16x32_bf16 v[228:231], v[8:11], v[180:183], v[228:231]
    v_mfma_f32_16x16x32_bf16 v[232:235], v[12:15], v[180:183], v[232:235]
    v_mfma_f32_16x16x32_bf16 v[236:239], v[16:19], v[180:183], v[236:239]
    v_mfma_f32_16x16x32_bf16 v[240:243], v[20:23], v[180:183], v[240:243]
    v_mfma_f32_16x16x32_bf16 v[244:247], v[24:27], v[180:183], v[244:247]
    s_waitcnt lgkmcnt(5)
    s_waitcnt vmcnt(16)
    v_mfma_f32_16x16x32_bf16 v[208:211], v[64:67], v[184:187], v[208:211]
    ds_read_b128 v[8:11], v3 offset:0
    v_mfma_f32_16x16x32_bf16 v[212:215], v[68:71], v[184:187], v[212:215]
    ds_read_b128 v[12:15], v3 offset:1024
    v_mfma_f32_16x16x32_bf16 v[216:219], v[72:75], v[184:187], v[216:219]
    ds_read_b128 v[16:19], v3 offset:2048
    v_mfma_f32_16x16x32_bf16 v[220:223], v[76:79], v[184:187], v[220:223]
    ds_read_b128 v[20:23], v3 offset:3072
    v_mfma_f32_16x16x32_bf16 v[224:227], v[80:83], v[184:187], v[224:227]
    ds_read_b128 v[24:27], v3 offset:4096
    v_mfma_f32_16x16x32_bf16 v[228:231], v[64:67], v[188:191], v[228:231]
    v_mfma_f32_16x16x32_bf16 v[232:235], v[68:71], v[188:191], v[232:235]
    v_mfma_f32_16x16x32_bf16 v[236:239], v[72:75], v[188:191], v[236:239]
    v_mfma_f32_16x16x32_bf16 v[240:243], v[76:79], v[188:191], v[240:243]
    v_mfma_f32_16x16x32_bf16 v[244:247], v[80:83], v[188:191], v[244:247]
    s_cmp_eq_u32 s79, 0
    s_cbranch_scc1 L_R13_8
    s_waitcnt lgkmcnt(5)
    s_waitcnt vmcnt(14)
    v_mfma_f32_16x16x32_bf16 v[208:211], v[28:31], v[200:203], v[208:211]
    v_mfma_f32_16x16x32_bf16 v[212:215], v[32:35], v[200:203], v[212:215]
    v_mfma_f32_16x16x32_bf16 v[216:219], v[36:39], v[200:203], v[216:219]
    v_mfma_f32_16x16x32_bf16 v[220:223], v[40:43], v[200:203], v[220:223]
    v_mfma_f32_16x16x32_bf16 v[224:227], v[44:47], v[200:203], v[224:227]
    v_mfma_f32_16x16x32_bf16 v[228:231], v[28:31], v[204:207], v[228:231]
    v_mfma_f32_16x16x32_bf16 v[232:235], v[32:35], v[204:207], v[232:235]
    v_mfma_f32_16x16x32_bf16 v[236:239], v[36:39], v[204:207], v[236:239]
    v_mfma_f32_16x16x32_bf16 v[240:243], v[40:43], v[204:207], v[240:243]
    v_mfma_f32_16x16x32_bf16 v[244:247], v[44:47], v[204:207], v[244:247]
L_R13_8:
    s_waitcnt lgkmcnt(0)
    s_waitcnt vmcnt(12)
    v_mfma_f32_16x16x32_bf16 v[228:231], v[8:11], v[196:199], v[228:231]
    v_mfma_f32_16x16x32_bf16 v[232:235], v[12:15], v[196:199], v[232:235]
    v_mfma_f32_16x16x32_bf16 v[236:239], v[16:19], v[196:199], v[236:239]
    s_nop 5
    ds_write_b128 v55, v[228:231] offset:0
    v_mfma_f32_16x16x32_bf16 v[240:243], v[20:23], v[196:199], v[240:243]
    ds_write_b128 v55, v[232:235] offset:1024
    v_mfma_f32_16x16x32_bf16 v[244:247], v[24:27], v[196:199], v[244:247]
    ds_write_b128 v55, v[236:239] offset:2048
    v_mfma_f32_16x16x32_bf16 v[208:211], v[8:11], v[192:195], v[208:211]
    s_nop 3
    ds_write_b128 v55, v[240:243] offset:3072
    v_mfma_f32_16x16x32_bf16 v[212:215], v[12:15], v[192:195], v[212:215]
    ds_write_b128 v55, v[244:247] offset:4096
    v_mfma_f32_16x16x32_bf16 v[216:219], v[16:19], v[192:195], v[216:219]
    v_mfma_f32_16x16x32_bf16 v[220:223], v[20:23], v[192:195], v[220:223]
    v_mfma_f32_16x16x32_bf16 v[224:227], v[24:27], v[192:195], v[224:227]
    s_waitcnt lgkmcnt(0)
    s_barrier
    ds_read_b128 v[228:231], v56 offset:0
    ds_read_b128 v[232:235], v56 offset:1024
    ds_read_b128 v[236:239], v56 offset:2048
    ds_read_b128 v[240:243], v56 offset:3072
    ds_read_b128 v[244:247], v56 offset:4096
    s_add_u32 s98, s52, 4096
    s_waitcnt lgkmcnt(0)
    v_add_f32 v208, v208, v228
    v_add_f32 v209, v209, v229
    v_add_f32 v210, v210, v230
    v_add_f32 v211, v211, v231
    v_perm_b32 v208, v208, v54, s55
    v_perm_b32 v210, v210, v54, s55
    buffer_store_dwordx4 v[208:211], v2, s[12:15], s52 offen sc1
    v_add_f32 v212, v212, v232
    v_add_f32 v213, v213, v233
    v_add_f32 v214, v214, v234
    v_add_f32 v215, v215, v235
    v_perm_b32 v212, v212, v54, s55
    v_perm_b32 v214, v214, v54, s55
    buffer_store_dwordx4 v[212:215], v2, s[12:15], s52 offen offset:1024 sc1
    v_add_f32 v216, v216, v236
    v_add_f32 v217, v217, v237
    v_add_f32 v218, v218, v238
    v_add_f32 v219, v219, v239
    v_perm_b32 v216, v216, v54, s55
    v_perm_b32 v218, v218, v54, s55
    buffer_store_dwordx4 v[216:219], v2, s[12:15], s52 offen offset:2048 sc1
    v_add_f32 v220, v220, v240
    v_add_f32 v221, v221, v241
    v_add_f32 v222, v222, v242
    v_add_f32 v223, v223, v243
    v_perm_b32 v220, v220, v54, s55
    v_perm_b32 v222, v222, v54, s55
    buffer_store_dwordx4 v[220:223], v2, s[12:15], s52 offen offset:3072 sc1
    v_add_f32 v224, v224, v244
    v_add_f32 v225, v225, v245
    v_add_f32 v226, v226, v246
    v_add_f32 v227, v227, v247
    v_perm_b32 v224, v224, v54, s55
    v_perm_b32 v226, v226, v54, s55
    buffer_store_dwordx4 v[224:227], v2, s[12:15], s98 offen sc1
    s_xor_b32 s46, s67, 2
    s_mul_i32 s46, s46, 5120
    s_add_u32 s96, s46, s19
    s_add_u32 m0, s46, 61440
    s_add_u32 s47, s96, 81920
    buffer_load_dwordx4 v2, s[12:15], s47 offen sc1 lds
    buffer_load_dwordx4 v2, s[12:15], s47 offen offset:1024 sc1 lds
    buffer_load_dwordx4 v2, s[12:15], s47 offen offset:2048 sc1 lds
    buffer_load_dwordx4 v2, s[12:15], s47 offen offset:3072 sc1 lds
    s_add_u32 m0, s46, 65536
    s_add_u32 s47, s96, 86016
    buffer_load_dwordx4 v2, s[12:15], s47 offen sc1 lds
    s_waitcnt vmcnt(12)
    s_barrier
    s_waitcnt vmcnt(0)
    s_barrier
    s_barrier
    s_endpgm
L_OWN_7:
    ds_read_b128 v[8:11], v3 offset:0
    ds_read_b128 v[12:15], v3 offset:1024
    ds_read_b128 v[16:19], v3 offset:2048
    ds_read_b128 v[20:23], v3 offset:3072
    ds_read_b128 v[24:27], v3 offset:4096
    ds_read_b128 v[28:31], v3 offset:10240
    ds_read_b128 v[32:35], v3 offset:11264
    ds_read_b128 v[36:39], v3 offset:12288
    ds_read_b128 v[40:43], v3 offset:13312
    ds_read_b128 v[44:47], v3 offset:14336
    v_cvt_pk_bf16_f32 v168, v64, v65
    v_cvt_pk_bf16_f32 v169, v66, v67
    v_cvt_pk_bf16_f32 v170, v68, v69
    v_cvt_pk_bf16_f32 v171, v70, v71
    v_cvt_pk_bf16_f32 v176, v72, v73
    v_cvt_pk_bf16_f32 v178, v88, v89
    v_cvt_pk_bf16_f32 v177, v74, v75
    v_cvt_pk_bf16_f32 v179, v90, v91
    v_mfma_f32_32x32x16_bf16 v[208:223], v[184:187], v[168:171], 0
    v_cvt_pk_bf16_f32 v180, v76, v77
    v_cvt_pk_bf16_f32 v181, v78, v79
    s_add_u32 s99, s18, 114688
    s_add_u32 m0, s69, 114688
    s_mov_b64 exec, s[4:5]
    buffer_load_dwordx4 v2, s[12:15], s99 offen sc1 lds
    s_mov_b64 exec, -1
    v_cvt_pk_bf16_f32 v182, v92, v93
    v_cvt_pk_bf16_f32 v183, v94, v95
    v_mfma_f32_32x32x16_bf16 v[208:223], v[188:191], v[176:179], v[208:223]
    v_cvt_pk_bf16_f32 v172, v80, v81
    v_cvt_pk_bf16_f32 v173, v82, v83
    v_cvt_pk_bf16_f32 v174, v84, v85
    v_cvt_pk_bf16_f32 v175, v86, v87
    v_mul_f32 v6, s20, v92
    v_mov_b32 v61, 0x3f80
    v_mfma_f32_32x32x16_bf16 v[64:79], v[196:199], v[168:171], 0
    s_mov_b32 vcc_lo, 0
    s_mov_b32 vcc_hi, -1
    v_cndmask_b32_e32 v182, v182, v61, vcc
    v_cndmask_b32_e64 v183, v183, 0, vcc
    v_cndmask_b32_e64 v51, 2.0, v51, vcc
    s_mov_b64 exec, s[4:5]
    buffer_load_dwordx4 v2, s[12:15], s99 offen offset:1024 sc1 lds
    s_mov_b64 exec, -1
    v_mfma_f32_32x32x16_bf16 v[64:79], v[204:207], v[176:179], v[64:79]
    ds_write_b128 v48, v[176:179] offset:256
    v_mfma_f32_32x32x16_bf16 v[64:79], v[200:203], v[172:175], v[64:79]
    ds_write_b128 v49, v[180:183] offset:256
    v_mfma_f32_32x32x16_bf16 v[80:95], v[184:187], v[172:175], 0
    v_mfma_f32_32x32x16_bf16 v[80:95], v[192:195], v[176:179], v[80:95]
    v_max3_f32 v58, v208, v209, v210
    v_max3_f32 v59, v211, v212, v213
    v_max3_f32 v58, v58, v214, v215
    v_max3_f32 v59, v59, v216, v217
    v_max3_f32 v58, v58, v218, v219
    buffer_load_dwordx4 v[104:107], v2, s[12:15], s16 offen offset:2048 sc1
    v_max3_f32 v59, v59, v220, v221
    v_max3_f32 v58, v58, v222, v223
    s_nop 0
    v_max3_f32 v59, v59, v64, v65
    v_max3_f32 v58, v58, v66, v67
    v_max_f32 v58, v58, v59
    v_mul_f32 v58, s32, v58
    v_pk_fma_f32 v[208:209], v[208:209], s[20:21], v[58:59] op_sel_hi:[1,1,0]
    v_pk_fma_f32 v[210:211], v[210:211], s[20:21], v[58:59] op_sel_hi:[1,1,0]
    v_exp_f32 v208, v208
    v_exp_f32 v209, v209
    v_pk_fma_f32 v[212:213], v[212:213], s[20:21], v[58:59] op_sel_hi:[1,1,0]
    buffer_load_dwordx4 v[108:111], v2, s[12:15], s17 offen offset:2048 sc1
    v_exp_f32 v210, v210
    v_exp_f32 v211, v211
    v_pk_fma_f32 v[214:215], v[214:215], s[20:21], v[58:59] op_sel_hi:[1,1,0]
    v_exp_f32 v212, v212
    v_exp_f32 v213, v213
    v_pk_add_f32 v[60:61], v[208:209], v[210:211]
    v_pk_fma_f32 v[216:217], v[216:217], s[20:21], v[58:59] op_sel_hi:[1,1,0]
    v_exp_f32 v214, v214
    v_exp_f32 v215, v215
    v_pk_add_f32 v[60:61], v[60:61], v[212:213]
    v_pk_fma_f32 v[218:219], v[218:219], s[20:21], v[58:59] op_sel_hi:[1,1,0]
    s_add_u32 s96, s96, 4096
    buffer_load_dwordx4 v[112:115], v0, s[12:15], s96 offen sc1
    v_exp_f32 v216, v216
    v_exp_f32 v217, v217
    v_pk_add_f32 v[60:61], v[60:61], v[214:215]
    v_pk_fma_f32 v[220:221], v[220:221], s[20:21], v[58:59] op_sel_hi:[1,1,0]
    v_exp_f32 v218, v218
    v_exp_f32 v219, v219
    v_pk_add_f32 v[60:61], v[60:61], v[216:217]
    v_pk_fma_f32 v[222:223], v[222:223], s[20:21], v[58:59] op_sel_hi:[1,1,0]
    v_exp_f32 v220, v220
    v_exp_f32 v221, v221
    v_pk_add_f32 v[60:61], v[60:61], v[218:219]
    buffer_load_dwordx4 v[116:119], v5, s[12:15], s96 offen sc1
    v_pk_fma_f32 v[64:65], v[64:65], s[20:21], v[58:59] op_sel_hi:[1,1,0]
    v_exp_f32 v222, v222
    v_exp_f32 v223, v223
    v_pk_add_f32 v[60:61], v[60:61], v[220:221]
    v_pk_fma_f32 v[66:67], v[66:67], s[20:21], v[58:59] op_sel_hi:[1,1,0]
    v_exp_f32 v64, v64
    v_exp_f32 v65, v65
    v_pk_add_f32 v[60:61], v[60:61], v[222:223]
    v_exp_f32 v66, v66
    v_exp_f32 v67, v67
    v_pk_add_f32 v[60:61], v[60:61], v[64:65]
    s_waitcnt vmcnt(12)
    buffer_load_dwordx4 v[120:123], v0, s[12:15], s96 offen offset:2048 sc1
    v_pk_add_f32 v[60:61], v[60:61], v[66:67]
    v_add_f32 v60, v60, v61
    v_rcp_f32 v60, v60
    s_nop 0
    v_pk_mul_f32 v[208:209], v[208:209], v[60:61] op_sel_hi:[1,0]
    v_pk_mul_f32 v[210:211], v[210:211], v[60:61] op_sel_hi:[1,0]
    v_pk_mul_f32 v[212:213], v[212:213], v[60:61] op_sel_hi:[1,0]
    v_pk_mul_f32 v[214:215], v[214:215], v[60:61] op_sel_hi:[1,0]
    v_cvt_pk_bf16_f32 v184, v208, v209
    v_cvt_pk_bf16_f32 v185, v210, v211
    v_cvt_pk_bf16_f32 v186, v212, v213
    v_cvt_pk_bf16_f32 v187, v214, v215
    buffer_load_dwordx4 v[124:127], v5, s[12:15], s96 offen offset:2048 sc1
    ds_write_b128 v48, v[184:187]
    v_pk_mul_f32 v[216:217], v[216:217], v[60:61] op_sel_hi:[1,0]
    v_pk_mul_f32 v[218:219], v[218:219], v[60:61] op_sel_hi:[1,0]
    v_pk_mul_f32 v[220:221], v[220:221], v[60:61] op_sel_hi:[1,0]
    v_pk_mul_f32 v[222:223], v[222:223], v[60:61] op_sel_hi:[1,0]
    v_cvt_pk_bf16_f32 v188, v216, v217
    v_cvt_pk_bf16_f32 v189, v218, v219
    v_cvt_pk_bf16_f32 v190, v220, v221
    v_cvt_pk_bf16_f32 v191, v222, v223
    ds_write_b128 v49, v[188:191]
    v_pk_mul_f32 v[64:65], v[64:65], v[60:61] op_sel_hi:[1,0]
    v_pk_mul_f32 v[66:67], v[66:67], v[60:61] op_sel_hi:[1,0]
    v_cvt_pk_bf16_f32 v192, v64, v65
    v_cvt_pk_bf16_f32 v193, v66, v67
    ds_write_b64 v50, v[192:193] offset:256
    s_waitcnt vmcnt(10)
    s_waitcnt lgkmcnt(0)
    s_barrier
    s_setprio 1
    ds_read_b64_tr_b16 v[224:225], v52 offset:0
    ds_read_b64_tr_b16 v[226:227], v53 offset:512
    ds_read_b64_tr_b16 v[228:229], v54 offset:256
    ds_read_b64_tr_b16 v[230:231], v55 offset:768
    ds_read_b64_tr_b16 v[232:233], v52 offset:2048
    ds_read_b64_tr_b16 v[234:235], v53 offset:2560
    ds_read_b64_tr_b16 v[236:237], v54 offset:2304
    ds_read_b64_tr_b16 v[238:239], v55 offset:2816
    ds_read_b64_tr_b16 v[240:241], v52 offset:4096
    ds_read_b64_tr_b16 v[242:243], v53 offset:4608
    ds_read_b64_tr_b16 v[244:245], v54 offset:4352
    ds_read_b64_tr_b16 v[246:247], v55 offset:4864
    s_waitcnt lgkmcnt(8)
    v_mfma_f32_32x32x16_bf16 v[208:223], v[224:227], v[228:231], 0
    s_add_u32 s99, s18, 122880
    s_add_u32 m0, s69, 0
    s_nop 0
    buffer_load_dwordx4 v2, s[12:15], s99 offen sc1 lds
    s_waitcnt lgkmcnt(4)
    v_mfma_f32_32x32x16_bf16 v[208:223], v[232:235], v[236:239], v[208:223]
    ds_read_b64_tr_b16 v[224:225], v52 offset:6144
    ds_read_b64_tr_b16 v[226:227], v53 offset:6656
    ds_read_b64_tr_b16 v[228:229], v54 offset:6400
    ds_read_b64_tr_b16 v[230:231], v55 offset:6912
    buffer_load_dwordx4 v2, s[12:15], s99 offen offset:1024 sc1 lds
    s_waitcnt lgkmcnt(4)
    v_mfma_f32_32x32x16_bf16 v[208:223], v[240:243], v[244:247], v[208:223]
    ds_read_b64_tr_b16 v[232:233], v52 offset:8192
    ds_read_b64_tr_b16 v[234:235], v53 offset:8704
    ds_read_b64_tr_b16 v[236:237], v54 offset:8448
    ds_read_b64_tr_b16 v[238:239], v55 offset:8960
    s_add_u32 s96, s96, 4096
    buffer_load_dwordx4 v[128:131], v0, s[12:15], s96 offen sc1
    s_waitcnt lgkmcnt(4)
    v_mfma_f32_32x32x16_bf16 v[208:223], v[224:227], v[228:231], v[208:223]
    ds_read_b64_tr_b16 v[240:241], v52 offset:10240
    ds_read_b64_tr_b16 v[242:243], v53 offset:10752
    ds_read_b64_tr_b16 v[244:245], v54 offset:10496
    ds_read_b64_tr_b16 v[246:247], v55 offset:11008
    s_waitcnt lgkmcnt(4)
    v_mfma_f32_32x32x16_bf16 v[208:223], v[232:235], v[236:239], v[208:223]
    ds_read_b64_tr_b16 v[224:225], v52 offset:12288
    ds_read_b64_tr_b16 v[226:227], v53 offset:12800
    ds_read_b64_tr_b16 v[228:229], v54 offset:12544
    ds_read_b64_tr_b16 v[230:231], v55 offset:13056
    s_waitcnt lgkmcnt(4)
    v_mfma_f32_32x32x16_bf16 v[208:223], v[240:243], v[244:247], v[208:223]
    ds_read_b64_tr_b16 v[232:233], v52 offset:14336
    ds_read_b64_tr_b16 v[234:235], v53 offset:14848
    ds_read_b64_tr_b16 v[236:237], v54 offset:14592
    ds_read_b64_tr_b16 v[238:239], v55 offset:15104
    s_waitcnt lgkmcnt(4)
    v_mfma_f32_32x32x16_bf16 v[208:223], v[224:227], v[228:231], v[208:223]
    s_waitcnt lgkmcnt(0)
    v_mfma_f32_32x32x16_bf16 v[208:223], v[232:235], v[236:239], v[208:223]
    s_nop 7
    s_nop 3
    v_cvt_pk_bf16_f32 v224, v208, v209
    v_cvt_pk_bf16_f32 v225, v210, v211
    v_cvt_pk_bf16_f32 v226, v212, v213
    v_cvt_pk_bf16_f32 v227, v214, v215
    s_nop 0
    v_permlane32_swap_b32 v224, v226
    v_permlane32_swap_b32 v225, v227
    s_cmp_eq_u32 s60, s101
    s_cselect_b64 exec, 0, -1
    buffer_store_dwordx4 v[224:227], v56, s[12:15], s60 offen offset:0 sc1
    s_mov_b64 exec, -1
    v_cvt_pk_bf16_f32 v228, v216, v217
    v_cvt_pk_bf16_f32 v229, v218, v219
    v_cvt_pk_bf16_f32 v230, v220, v221
    v_cvt_pk_bf16_f32 v231, v222, v223
    s_nop 0
    v_permlane32_swap_b32 v228, v230
    v_permlane32_swap_b32 v229, v231
    s_cmp_eq_u32 s61, s101
    s_cselect_b64 exec, 0, -1
    buffer_store_dwordx4 v[228:231], v56, s[12:15], s61 offen offset:672 sc1
    s_mov_b64 exec, -1
    s_setprio 1
    s_barrier
    s_waitcnt vmcnt(13)
    v_mfma_f32_16x16x32_bf16 v[208:211], v[8:11], v[96:99], 0
    v_min_f32 v6, 0x42700000, v6
    v_exp_f32 v6, v6
    v_mfma_f32_16x16x32_bf16 v[212:215], v[12:15], v[96:99], 0
    buffer_load_dwordx4 v[132:135], v5, s[12:15], s96 offen sc1
    v_add_f32 v61, 1.0, v6
    v_mov_b32 v62, v6
    v_mfma_f32_16x16x32_bf16 v[216:219], v[16:19], v[96:99], 0
    v_rcp_f32 v61, v61
    v_permlane32_swap_b32 v62, v6
    s_cmp_eq_u32 s23, s101
    s_cselect_b64 exec, 0, -1
    buffer_store_dword v61, v51, s[12:15], s23 offen sc1
    s_mov_b64 exec, -1
    v_mfma_f32_16x16x32_bf16 v[220:223], v[20:23], v[96:99], 0
    buffer_load_dwordx4 v[136:139], v0, s[12:15], s96 offen offset:2048 sc1
    v_max3_f32 v58, v80, v81, v82
    v_max3_f32 v59, v83, v84, v85
    v_mfma_f32_16x16x32_bf16 v[224:227], v[24:27], v[96:99], 0
    v_max3_f32 v58, v58, v86, v87
    v_max3_f32 v59, v59, v88, v89
    v_max3_f32 v58, v58, v90, v91
    v_mfma_f32_16x16x32_bf16 v[228:231], v[8:11], v[100:103], 0
    buffer_load_dwordx4 v[140:143], v5, s[12:15], s96 offen offset:2048 sc1
    v_max3_f32 v59, v59, v92, v93
    v_max3_f32 v58, v58, v94, v95
    v_mfma_f32_16x16x32_bf16 v[232:235], v[12:15], v[100:103], 0
    v_max3_f32 v59, v59, v68, v69
    v_max3_f32 v58, v58, v70, v71
    v_max_f32 v58, v58, v59
    v_mfma_f32_16x16x32_bf16 v[236:239], v[16:19], v[100:103], 0
    s_add_u32 s96, s96, 4096
    buffer_load_dwordx4 v[144:147], v0, s[12:15], s96 offen sc1
    v_mul_f32 v58, s32, v58
    v_fma_f32 v80, v80, s20, v58
    v_mfma_f32_16x16x32_bf16 v[240:243], v[20:23], v[100:103], 0
    v_fma_f32 v81, v81, s20, v58
    v_fma_f32 v82, v82, s20, v58
    v_fma_f32 v83, v83, s20, v58
    v_mfma_f32_16x16x32_bf16 v[244:247], v[24:27], v[100:103], 0
    buffer_load_dwordx4 v[148:151], v5, s[12:15], s96 offen sc1
    v_exp_f32 v80, v80
    v_exp_f32 v81, v81
    s_waitcnt vmcnt(15)
    v_mfma_f32_16x16x32_bf16 v[208:211], v[28:31], v[104:107], v[208:211]
    ds_read_b128 v[8:11], v3 offset:20480
    v_fma_f32 v84, v84, s20, v58
    v_fma_f32 v85, v85, s20, v58
    v_mfma_f32_16x16x32_bf16 v[212:215], v[32:35], v[104:107], v[212:215]
    ds_read_b128 v[12:15], v3 offset:21504
    buffer_load_dwordx4 v[152:155], v0, s[12:15], s96 offen offset:2048 sc1
    v_exp_f32 v82, v82
    v_mfma_f32_16x16x32_bf16 v[216:219], v[36:39], v[104:107], v[216:219]
    ds_read_b128 v[16:19], v3 offset:22528
    v_exp_f32 v83, v83
    v_fma_f32 v86, v86, s20, v58
    v_mfma_f32_16x16x32_bf16 v[220:223], v[40:43], v[104:107], v[220:223]
    ds_read_b128 v[20:23], v3 offset:23552
    buffer_load_dwordx4 v[156:159], v5, s[12:15], s96 offen offset:2048 sc1
    v_fma_f32 v87, v87, s20, v58
    v_mfma_f32_16x16x32_bf16 v[224:227], v[44:47], v[104:107], v[224:227]
    ds_read_b128 v[24:27], v3 offset:24576
    v_exp_f32 v84, v84
    v_exp_f32 v85, v85
    v_mfma_f32_16x16x32_bf16 v[228:231], v[28:31], v[108:111], v[228:231]
    s_add_u32 s96, s96, 4096
    buffer_load_dwordx4 v[160:163], v0, s[12:15], s96 offen sc1
    v_add_f32 v60, v80, v82
    v_add_f32 v61, v81, v83
    v_mfma_f32_16x16x32_bf16 v[232:235], v[32:35], v[108:111], v[232:235]
    v_fma_f32 v88, v88, s20, v58
    v_fma_f32 v89, v89, s20, v58
    v_exp_f32 v86, v86
    v_mfma_f32_16x16x32_bf16 v[236:239], v[36:39], v[108:111], v[236:239]
    buffer_load_dwordx4 v[164:167], v5, s[12:15], s96 offen sc1
    v_exp_f32 v87, v87
    v_add_f32 v60, v60, v84
    v_mfma_f32_16x16x32_bf16 v[240:243], v[40:43], v[108:111], v[240:243]
    v_add_f32 v61, v61, v85
    v_fma_f32 v90, v90, s20, v58
    v_fma_f32 v91, v91, s20, v58
    v_mfma_f32_16x16x32_bf16 v[244:247], v[44:47], v[108:111], v[244:247]
    buffer_load_dwordx4 v[168:171], v0, s[12:15], s96 offen offset:2048 sc1
    v_exp_f32 v88, v88
    v_exp_f32 v89, v89
    s_waitcnt lgkmcnt(0)
    s_waitcnt vmcnt(18)
    v_mfma_f32_16x16x32_bf16 v[208:211], v[8:11], v[112:115], v[208:211]
    ds_read_b128 v[28:31], v3 offset:30720
    v_add_f32 v60, v60, v86
    v_add_f32 v61, v61, v87
    v_mfma_f32_16x16x32_bf16 v[212:215], v[12:15], v[112:115], v[212:215]
    ds_read_b128 v[32:35], v3 offset:31744
    buffer_load_dwordx4 v[172:175], v5, s[12:15], s96 offen offset:2048 sc1
    v_fma_f32 v92, v92, s20, v58
    v_mfma_f32_16x16x32_bf16 v[216:219], v[16:19], v[112:115], v[216:219]
    ds_read_b128 v[36:39], v3 offset:32768
    v_fma_f32 v93, v93, s20, v58
    v_exp_f32 v90, v90
    v_mfma_f32_16x16x32_bf16 v[220:223], v[20:23], v[112:115], v[220:223]
    ds_read_b128 v[40:43], v3 offset:33792
    s_add_u32 s96, s96, 4096
    buffer_load_dwordx4 v[176:179], v0, s[12:15], s96 offen sc1
    v_exp_f32 v91, v91
    v_mfma_f32_16x16x32_bf16 v[224:227], v[24:27], v[112:115], v[224:227]
    ds_read_b128 v[44:47], v3 offset:34816
    v_add_f32 v60, v60, v88
    v_add_f32 v61, v61, v89
    v_mfma_f32_16x16x32_bf16 v[228:231], v[8:11], v[116:119], v[228:231]
    buffer_load_dwordx4 v[180:183], v5, s[12:15], s96 offen sc1
    v_fma_f32 v94, v94, s20, v58
    v_fma_f32 v95, v95, s20, v58
    v_mfma_f32_16x16x32_bf16 v[232:235], v[12:15], v[116:119], v[232:235]
    v_exp_f32 v92, v92
    v_exp_f32 v93, v93
    v_add_f32 v60, v60, v90
    v_mfma_f32_16x16x32_bf16 v[236:239], v[16:19], v[116:119], v[236:239]
    v_add_f32 v61, v61, v91
    v_fma_f32 v68, v68, s20, v58
    v_fma_f32 v69, v69, s20, v58
    v_mfma_f32_16x16x32_bf16 v[240:243], v[20:23], v[116:119], v[240:243]
    v_exp_f32 v94, v94
    v_exp_f32 v95, v95
    v_add_f32 v60, v60, v92
    v_mfma_f32_16x16x32_bf16 v[244:247], v[24:27], v[116:119], v[244:247]
    v_add_f32 v61, v61, v93
    v_fma_f32 v70, v70, s20, v58
    v_fma_f32 v71, v71, s20, v58
    s_waitcnt lgkmcnt(0)
    s_waitcnt vmcnt(19)
    v_mfma_f32_16x16x32_bf16 v[208:211], v[28:31], v[120:123], v[208:211]
    ds_read_b128 v[8:11], v3 offset:40960
    v_exp_f32 v68, v68
    v_exp_f32 v69, v69
    v_mfma_f32_16x16x32_bf16 v[212:215], v[32:35], v[120:123], v[212:215]
    ds_read_b128 v[12:15], v3 offset:41984
    v_add_f32 v60, v60, v94
    v_add_f32 v61, v61, v95
    v_mfma_f32_16x16x32_bf16 v[216:219], v[36:39], v[120:123], v[216:219]
    ds_read_b128 v[16:19], v3 offset:43008
    v_exp_f32 v70, v70
    v_exp_f32 v71, v71
    v_mfma_f32_16x16x32_bf16 v[220:223], v[40:43], v[120:123], v[220:223]
    ds_read_b128 v[20:23], v3 offset:44032
    v_add_f32 v60, v60, v68
    v_add_f32 v61, v61, v69
    v_mfma_f32_16x16x32_bf16 v[224:227], v[44:47], v[120:123], v[224:227]
    ds_read_b128 v[24:27], v3 offset:45056
    v_add_f32 v60, v60, v70
    v_add_f32 v61, v61, v71
    v_mfma_f32_16x16x32_bf16 v[228:231], v[28:31], v[124:127], v[228:231]
    v_add_f32 v60, v60, v61
    v_rcp_f32 v60, v60
    s_nop 0
    v_mul_f32 v80, v80, v60
    v_mfma_f32_16x16x32_bf16 v[232:235], v[32:35], v[124:127], v[232:235]
    v_mul_f32 v81, v81, v60
    v_mul_f32 v82, v82, v60
    v_mul_f32 v83, v83, v60
    v_mfma_f32_16x16x32_bf16 v[236:239], v[36:39], v[124:127], v[236:239]
    v_mul_f32 v84, v84, v60
    v_mul_f32 v85, v85, v60
    v_mul_f32 v86, v86, v60
    v_mfma_f32_16x16x32_bf16 v[240:243], v[40:43], v[124:127], v[240:243]
    v_mul_f32 v87, v87, v60
    v_cvt_pk_bf16_f32 v72, v80, v81
    v_cvt_pk_bf16_f32 v73, v82, v83
    v_mfma_f32_16x16x32_bf16 v[244:247], v[44:47], v[124:127], v[244:247]
    v_cvt_pk_bf16_f32 v74, v84, v85
    v_cvt_pk_bf16_f32 v75, v86, v87
    v_mul_f32 v88, v88, v60
    s_waitcnt lgkmcnt(0)
    s_waitcnt vmcnt(13)
    v_mfma_f32_16x16x32_bf16 v[208:211], v[8:11], v[128:131], v[208:211]
    ds_read_b128 v[28:31], v3 offset:51200
    v_mul_f32 v89, v89, v60
    v_mul_f32 v90, v90, v60
    v_mfma_f32_16x16x32_bf16 v[212:215], v[12:15], v[128:131], v[212:215]
    ds_read_b128 v[32:35], v3 offset:52224
    v_mul_f32 v91, v91, v60
    v_mul_f32 v92, v92, v60
    v_mfma_f32_16x16x32_bf16 v[216:219], v[16:19], v[128:131], v[216:219]
    ds_read_b128 v[36:39], v3 offset:53248
    v_mul_f32 v93, v93, v60
    v_mul_f32 v94, v94, v60
    v_mfma_f32_16x16x32_bf16 v[220:223], v[20:23], v[128:131], v[220:223]
    ds_read_b128 v[40:43], v3 offset:54272
    v_mul_f32 v95, v95, v60
    v_cvt_pk_bf16_f32 v76, v88, v89
    v_mfma_f32_16x16x32_bf16 v[224:227], v[24:27], v[128:131], v[224:227]
    ds_read_b128 v[44:47], v3 offset:55296
    v_cvt_pk_bf16_f32 v77, v90, v91
    v_cvt_pk_bf16_f32 v78, v92, v93
    v_mfma_f32_16x16x32_bf16 v[228:231], v[8:11], v[132:135], v[228:231]
    v_cvt_pk_bf16_f32 v79, v94, v95
    v_mul_f32 v68, v68, v60
    v_mul_f32 v69, v69, v60
    v_mfma_f32_16x16x32_bf16 v[232:235], v[12:15], v[132:135], v[232:235]
    v_mul_f32 v70, v70, v60
    v_mul_f32 v71, v71, v60
    v_cvt_pk_bf16_f32 v64, v68, v69
    v_mfma_f32_16x16x32_bf16 v[236:239], v[16:19], v[132:135], v[236:239]
    v_cvt_pk_bf16_f32 v65, v70, v71
    s_mov_b32 vcc_lo, 0
    s_mov_b32 vcc_hi, -1
    v_cndmask_b32_e32 v66, 0, v64, vcc
    v_cndmask_b32_e32 v67, 0, v65, vcc
    v_cndmask_b32_e64 v64, v64, 0, vcc
    v_cndmask_b32_e64 v65, v65, 0, vcc
    v_mov_b32 v61, 0x3f80
    v_mfma_f32_16x16x32_bf16 v[240:243], v[20:23], v[132:135], v[240:243]
    v_and_b32 v60, 1, v1
    v_lshlrev_b32 v60, 4, v60
    v_lshlrev_b32 v60, v60, v61
    v_mfma_f32_16x16x32_bf16 v[244:247], v[24:27], v[132:135], v[244:247]
    s_mov_b32 s50, 0x30003
    s_mov_b32 s51, 0x30003
    v_cndmask_b32_e64 v68, 0, v60, s[50:51]
    s_lshl_b64 s[50:51], s[50:51], 2
    v_cndmask_b32_e64 v69, 0, v60, s[50:51]
    s_lshl_b64 s[50:51], s[50:51], 2
    v_cndmask_b32_e64 v70, 0, v60, s[50:51]
    s_waitcnt lgkmcnt(0)
    s_waitcnt vmcnt(10)
    v_mfma_f32_16x16x32_bf16 v[208:211], v[28:31], v[136:139], v[208:211]
    ds_read_b128 v[8:11], v4 offset:0
    s_movk_i32 s99, 3584
    s_mul_i32 s28, s64, 57344
    s_add_u32 s28, s28, 16777216
    s_lshl_b32 s98, s67, 10
    v_and_b32 v53, 0xf0, v2
    v_add_u32 v53, s98, v53
    v_lshrrev_b32 v52, 4, v1
    v_cmp_gt_u32 vcc, 3104, v53
    s_cmp_eq_u32 s67, 3
    s_cselect_b32 s70, s101, 0
    v_mad_u32_u24 v52, v52, s99, v53
    v_cndmask_b32_e64 v53, 2.0, v52, vcc
    buffer_load_dwordx4 v[248:251], v52, s[12:15], s28 offen sc1
    s_lshl_b64 s[50:51], s[50:51], 2
    v_cndmask_b32_e64 v71, 0, v60, s[50:51]
    v_mfma_f32_16x16x32_bf16 v[212:215], v[32:35], v[136:139], v[212:215]
    ds_read_b128 v[12:15], v4 offset:1024
    buffer_load_dwordx4 v[252:255], v53, s[12:15], s28 offen offset:256 sc1
    s_lshl_b64 s[50:51], s[50:51], 2
    v_cndmask_b32_e64 v48, 0, v60, s[50:51]
    v_mfma_f32_16x16x32_bf16 v[216:219], v[36:39], v[136:139], v[216:219]
    ds_read_b128 v[16:19], v4 offset:2048
    s_or_b32 s46, s28, s70
    buffer_load_dwordx4 v[96:99], v52, s[12:15], s46 offen offset:512 sc1
    s_lshl_b64 s[50:51], s[50:51], 2
    v_cndmask_b32_e64 v49, 0, v60, s[50:51]
    v_mfma_f32_16x16x32_bf16 v[220:223], v[40:43], v[136:139], v[220:223]
    ds_read_b128 v[20:23], v4 offset:3072
    buffer_load_dwordx4 v[100:103], v52, s[12:15], s46 offen offset:768 sc1
    s_lshl_b64 s[50:51], s[50:51], 2
    v_cndmask_b32_e64 v50, 0, v60, s[50:51]
    v_mfma_f32_16x16x32_bf16 v[224:227], v[44:47], v[136:139], v[224:227]
    ds_read_b128 v[24:27], v4 offset:4096
    s_add_u32 s47, s28, 14336
    buffer_load_dwordx4 v[104:107], v52, s[12:15], s47 offen sc1
    s_lshl_b64 s[50:51], s[50:51], 2
    v_cndmask_b32_e64 v51, 0, v60, s[50:51]
    v_mfma_f32_16x16x32_bf16 v[228:231], v[28:31], v[140:143], v[228:231]
    buffer_load_dwordx4 v[108:111], v53, s[12:15], s47 offen offset:256 sc1
    v_and_b32 v62, 0xf0, v2
    v_lshrrev_b32 v60, 5, v1
    v_mfma_f32_16x16x32_bf16 v[232:235], v[32:35], v[140:143], v[232:235]
    s_or_b32 s46, s47, s70
    buffer_load_dwordx4 v[112:115], v52, s[12:15], s46 offen offset:512 sc1
    v_lshl_add_u32 v62, v60, 8, v62
    v_bfe_u32 v60, v1, 4, 1
    v_mfma_f32_16x16x32_bf16 v[236:239], v[36:39], v[140:143], v[236:239]
    buffer_load_dwordx4 v[116:119], v52, s[12:15], s46 offen offset:768 sc1
    v_lshl_add_u32 v62, v60, 3, v62
    s_lshl_b32 s40, s67, 10
    s_add_u32 s40, s40, 16384
    v_add_u32 v62, s40, v62
    v_mfma_f32_16x16x32_bf16 v[240:243], v[40:43], v[140:143], v[240:243]
    s_add_u32 s47, s28, 28672
    buffer_load_dwordx4 v[120:123], v52, s[12:15], s47 offen sc1
    v_bfe_u32 v60, v1, 3, 1
    v_and_b32 v61, 3, v1
    v_mfma_f32_16x16x32_bf16 v[244:247], v[44:47], v[140:143], v[244:247]
    buffer_load_dwordx4 v[124:127], v53, s[12:15], s47 offen offset:256 sc1
    v_lshl_add_u32 v60, v60, 2, v61
    v_and_b32 v61, 16, v1
    s_waitcnt lgkmcnt(0)
    s_waitcnt vmcnt(18)
    v_mfma_f32_16x16x32_bf16 v[208:211], v[8:11], v[144:147], v[208:211]
    ds_read_b128 v[28:31], v4 offset:10240
    s_or_b32 s46, s47, s70
    buffer_load_dwordx4 v[128:131], v52, s[12:15], s46 offen offset:512 sc1
    v_add_u32 v60, v60, v61
    v_mfma_f32_16x16x32_bf16 v[212:215], v[12:15], v[144:147], v[212:215]
    ds_read_b128 v[32:35], v4 offset:11264
    buffer_load_dwordx4 v[132:135], v52, s[12:15], s46 offen offset:768 sc1
    v_bfe_u32 v61, v1, 2, 1
    v_mfma_f32_16x16x32_bf16 v[216:219], v[16:19], v[144:147], v[216:219]
    ds_read_b128 v[36:39], v4 offset:12288
    s_add_u32 s47, s28, 43008
    buffer_load_dwordx4 v[80:83], v52, s[12:15], s47 offen sc1
    v_lshl_add_u32 v60, v61, 3, v60
    v_mfma_f32_16x16x32_bf16 v[220:223], v[20:23], v[144:147], v[220:223]
    ds_read_b128 v[40:43], v4 offset:13312
    buffer_load_dwordx4 v[84:87], v53, s[12:15], s47 offen offset:256 sc1
    v_min_u32 v60, 20, v60
    v_mfma_f32_16x16x32_bf16 v[224:227], v[24:27], v[144:147], v[224:227]
    ds_read_b128 v[44:47], v4 offset:14336
    s_or_b32 s46, s47, s70
    buffer_load_dwordx4 v[88:91], v52, s[12:15], s46 offen offset:512 sc1
    v_lshlrev_b32 v60, 4, v60
    v_mfma_f32_16x16x32_bf16 v[228:231], v[8:11], v[148:151], v[228:231]
    buffer_load_dwordx4 v[92:95], v52, s[12:15], s46 offen offset:768 sc1
    s_mul_i32 s40, s68, 1680
    s_add_u32 s40, s40, 16384
    v_add_u32 v54, s40, v60
    v_lshrrev_b32 v61, 5, v1
    v_mfma_f32_16x16x32_bf16 v[232:235], v[12:15], v[148:151], v[232:235]
    buffer_load_dwordx4 v[184:187], v0, s[12:15], s96 offen offset:2048 sc1
    v_mul_u32_u24 v61, 336, v61
    v_add_u32 v55, v54, v61
    v_mfma_f32_16x16x32_bf16 v[236:239], v[16:19], v[148:151], v[236:239]
    buffer_load_dwordx4 v[188:191], v5, s[12:15], s96 offen offset:2048 sc1
    v_mfma_f32_16x16x32_bf16 v[240:243], v[20:23], v[148:151], v[240:243]
    s_add_u32 s96, s96, 4096
    s_mov_b64 exec, s[8:9]
    buffer_load_dwordx4 v[200:203], v0, s[12:15], s96 offen offset:2048 sc1
    buffer_load_dwordx4 v[204:207], v5, s[12:15], s96 offen offset:2048 sc1
    s_mov_b64 exec, -1
    v_mfma_f32_16x16x32_bf16 v[244:247], v[24:27], v[148:151], v[244:247]
    buffer_load_dwordx4 v[192:195], v0, s[12:15], s96 offen sc1
    buffer_load_dwordx4 v[196:199], v5, s[12:15], s96 offen sc1
    s_waitcnt vmcnt(18)
    v_max_u32 v63, v248, v250
    v_max3_u32 v63, v63, v252, v254
    v_max3_u32 v63, v63, v96, v98
    v_max3_u32 v63, v63, v100, v102
    v_cmp_eq_u32 vcc, -1, v63
    s_mov_b32 s76, 2000
    s_cbranch_vccz L_RD_10
L_RL_9:
    s_sleep 1
    v_max_u32 v60, v248, v250
    v_cmp_eq_u32 vcc, -1, v60
    s_nop 0
    s_mov_b64 exec, vcc
    buffer_load_dwordx4 v[248:251], v52, s[12:15], s28 offen sc1
    s_mov_b64 exec, -1
    v_max_u32 v61, v252, v254
    v_cmp_eq_u32 vcc, -1, v61
    s_nop 0
    s_mov_b64 exec, vcc
    buffer_load_dwordx4 v[252:255], v53, s[12:15], s28 offen offset:256 sc1
    s_mov_b64 exec, -1
    v_max_u32 v60, v96, v98
    v_cmp_eq_u32 vcc, -1, v60
    s_nop 0
    s_mov_b64 exec, vcc
    s_or_b32 s46, s28, s70
    buffer_load_dwordx4 v[96:99], v52, s[12:15], s46 offen offset:512 sc1
    s_mov_b64 exec, -1
    v_max_u32 v61, v100, v102
    v_cmp_eq_u32 vcc, -1, v61
    s_nop 0
    s_mov_b64 exec, vcc
    buffer_load_dwordx4 v[100:103], v52, s[12:15], s46 offen offset:768 sc1
    s_mov_b64 exec, -1
    s_waitcnt vmcnt(0)
    s_sub_u32 s76, s76, 1
    s_cmp_eq_u32 s76, 0
    s_cbranch_scc1 L_RD_10
    v_max_u32 v63, v248, v250
    v_max3_u32 v63, v63, v252, v254
    v_max3_u32 v63, v63, v96, v98
    v_max3_u32 v63, v63, v100, v102
    v_cmp_eq_u32 vcc, -1, v63
    s_cbranch_vccnz L_RL_9
L_RD_10:
    v_mfma_f32_16x16x32_bf16 v[56:59], v[68:71], v[248:251], 0
    v_mfma_f32_16x16x32_bf16 v[8:11], v[68:71], v[96:99], 0
    v_mfma_f32_16x16x32_bf16 v[56:59], v[48:51], v[252:255], v[56:59]
    v_mfma_f32_16x16x32_bf16 v[8:11], v[48:51], v[100:103], v[8:11]
    s_waitcnt vmcnt(14)
    v_max_u32 v63, v104, v106
    v_max3_u32 v63, v63, v108, v110
    v_max3_u32 v63, v63, v112, v114
    v_max3_u32 v63, v63, v116, v118
    v_cmp_eq_u32 vcc, -1, v63
    s_mov_b32 s76, 2000
    s_cbranch_vccz L_RD_12
L_RL_11:
    s_sleep 1
    v_max_u32 v60, v104, v106
    v_cmp_eq_u32 vcc, -1, v60
    s_nop 0
    s_mov_b64 exec, vcc
    s_add_u32 s47, s28, 14336
    buffer_load_dwordx4 v[104:107], v52, s[12:15], s47 offen sc1
    s_mov_b64 exec, -1
    v_max_u32 v61, v108, v110
    v_cmp_eq_u32 vcc, -1, v61
    s_nop 0
    s_mov_b64 exec, vcc
    buffer_load_dwordx4 v[108:111], v53, s[12:15], s47 offen offset:256 sc1
    s_mov_b64 exec, -1
    v_max_u32 v60, v112, v114
    v_cmp_eq_u32 vcc, -1, v60
    s_nop 0
    s_mov_b64 exec, vcc
    s_or_b32 s46, s47, s70
    buffer_load_dwordx4 v[112:115], v52, s[12:15], s46 offen offset:512 sc1
    s_mov_b64 exec, -1
    v_max_u32 v61, v116, v118
    v_cmp_eq_u32 vcc, -1, v61
    s_nop 0
    s_mov_b64 exec, vcc
    buffer_load_dwordx4 v[116:119], v52, s[12:15], s46 offen offset:768 sc1
    s_mov_b64 exec, -1
    s_waitcnt vmcnt(0)
    s_sub_u32 s76, s76, 1
    s_cmp_eq_u32 s76, 0
    s_cbranch_scc1 L_RD_12
    v_max_u32 v63, v104, v106
    v_max3_u32 v63, v63, v108, v110
    v_max3_u32 v63, v63, v112, v114
    v_max3_u32 v63, v63, v116, v118
    v_cmp_eq_u32 vcc, -1, v63
    s_cbranch_vccnz L_RL_11
L_RD_12:
    v_mfma_f32_16x16x32_bf16 v[56:59], v[68:71], v[104:107], v[56:59]
    v_mfma_f32_16x16x32_bf16 v[8:11], v[68:71], v[112:115], v[8:11]
    v_mfma_f32_16x16x32_bf16 v[56:59], v[48:51], v[108:111], v[56:59]
    v_mfma_f32_16x16x32_bf16 v[8:11], v[48:51], v[116:119], v[8:11]
    s_waitcnt vmcnt(10)
    v_max_u32 v63, v120, v122
    v_max3_u32 v63, v63, v124, v126
    v_max3_u32 v63, v63, v128, v130
    v_max3_u32 v63, v63, v132, v134
    v_cmp_eq_u32 vcc, -1, v63
    s_mov_b32 s76, 2000
    s_cbranch_vccz L_RD_14
L_RL_13:
    s_sleep 1
    v_max_u32 v60, v120, v122
    v_cmp_eq_u32 vcc, -1, v60
    s_nop 0
    s_mov_b64 exec, vcc
    s_add_u32 s47, s28, 28672
    buffer_load_dwordx4 v[120:123], v52, s[12:15], s47 offen sc1
    s_mov_b64 exec, -1
    v_max_u32 v61, v124, v126
    v_cmp_eq_u32 vcc, -1, v61
    s_nop 0
    s_mov_b64 exec, vcc
    buffer_load_dwordx4 v[124:127], v53, s[12:15], s47 offen offset:256 sc1
    s_mov_b64 exec, -1
    v_max_u32 v60, v128, v130
    v_cmp_eq_u32 vcc, -1, v60
    s_nop 0
    s_mov_b64 exec, vcc
    s_or_b32 s46, s47, s70
    buffer_load_dwordx4 v[128:131], v52, s[12:15], s46 offen offset:512 sc1
    s_mov_b64 exec, -1
    v_max_u32 v61, v132, v134
    v_cmp_eq_u32 vcc, -1, v61
    s_nop 0
    s_mov_b64 exec, vcc
    buffer_load_dwordx4 v[132:135], v52, s[12:15], s46 offen offset:768 sc1
    s_mov_b64 exec, -1
    s_waitcnt vmcnt(0)
    s_sub_u32 s76, s76, 1
    s_cmp_eq_u32 s76, 0
    s_cbranch_scc1 L_RD_14
    v_max_u32 v63, v120, v122
    v_max3_u32 v63, v63, v124, v126
    v_max3_u32 v63, v63, v128, v130
    v_max3_u32 v63, v63, v132, v134
    v_cmp_eq_u32 vcc, -1, v63
    s_cbranch_vccnz L_RL_13
L_RD_14:
    v_mfma_f32_16x16x32_bf16 v[56:59], v[68:71], v[120:123], v[56:59]
    v_mfma_f32_16x16x32_bf16 v[8:11], v[68:71], v[128:131], v[8:11]
    v_mfma_f32_16x16x32_bf16 v[56:59], v[48:51], v[124:127], v[56:59]
    v_mfma_f32_16x16x32_bf16 v[8:11], v[48:51], v[132:135], v[8:11]
    s_waitcnt vmcnt(6)
    v_max_u32 v63, v80, v82
    v_max3_u32 v63, v63, v84, v86
    v_max3_u32 v63, v63, v88, v90
    v_max3_u32 v63, v63, v92, v94
    v_cmp_eq_u32 vcc, -1, v63
    s_mov_b32 s76, 2000
    s_cbranch_vccz L_RD_16
L_RL_15:
    s_sleep 1
    v_max_u32 v60, v80, v82
    v_cmp_eq_u32 vcc, -1, v60
    s_nop 0
    s_mov_b64 exec, vcc
    s_add_u32 s47, s28, 43008
    buffer_load_dwordx4 v[80:83], v52, s[12:15], s47 offen sc1
    s_mov_b64 exec, -1
    v_max_u32 v61, v84, v86
    v_cmp_eq_u32 vcc, -1, v61
    s_nop 0
    s_mov_b64 exec, vcc
    buffer_load_dwordx4 v[84:87], v53, s[12:15], s47 offen offset:256 sc1
    s_mov_b64 exec, -1
    v_max_u32 v60, v88, v90
    v_cmp_eq_u32 vcc, -1, v60
    s_nop 0
    s_mov_b64 exec, vcc
    s_or_b32 s46, s47, s70
    buffer_load_dwordx4 v[88:91], v52, s[12:15], s46 offen offset:512 sc1
    s_mov_b64 exec, -1
    v_max_u32 v61, v92, v94
    v_cmp_eq_u32 vcc, -1, v61
    s_nop 0
    s_mov_b64 exec, vcc
    buffer_load_dwordx4 v[92:95], v52, s[12:15], s46 offen offset:768 sc1
    s_mov_b64 exec, -1
    s_waitcnt vmcnt(0)
    s_sub_u32 s76, s76, 1
    s_cmp_eq_u32 s76, 0
    s_cbranch_scc1 L_RD_16
    v_max_u32 v63, v80, v82
    v_max3_u32 v63, v63, v84, v86
    v_max3_u32 v63, v63, v88, v90
    v_max3_u32 v63, v63, v92, v94
    v_cmp_eq_u32 vcc, -1, v63
    s_cbranch_vccnz L_RL_15
L_RD_16:
    v_mfma_f32_16x16x32_bf16 v[56:59], v[68:71], v[80:83], v[56:59]
    v_mfma_f32_16x16x32_bf16 v[8:11], v[68:71], v[88:91], v[8:11]
    v_mfma_f32_16x16x32_bf16 v[56:59], v[48:51], v[84:87], v[56:59]
    v_mfma_f32_16x16x32_bf16 v[8:11], v[48:51], v[92:95], v[8:11]
    s_nop 6
    v_cvt_pk_bf16_f32 v60, v56, v57
    v_cvt_pk_bf16_f32 v61, v58, v59
    ds_write_b64 v62, v[60:61]
    v_cvt_pk_bf16_f32 v12, v8, v9
    v_cvt_pk_bf16_f32 v13, v10, v11
    ds_write_b64 v62, v[12:13] offset:512
    s_waitcnt lgkmcnt(0)
    s_barrier
    s_setprio 1
    ds_read_b128 v[80:83], v55 offset:0
    ds_read_b128 v[84:87], v55 offset:672
    ds_read_b128 v[88:91], v54 offset:1344
    s_lshl_b32 s45, s68, 9
    s_add_u32 s45, s45, s29
    s_lshl3_add_u32 s44, s68, s29
    s_waitcnt lgkmcnt(2)
    v_mfma_f32_32x32x16_bf16 v[96:111], v[80:83], v[72:75], 0
    s_waitcnt lgkmcnt(1)
    v_mfma_f32_32x32x16_bf16 v[96:111], v[84:87], v[76:79], v[96:111]
    s_waitcnt lgkmcnt(0)
    v_mfma_f32_32x32x16_bf16 v[96:111], v[88:91], v[64:67], v[96:111]
    s_nop 7
    s_nop 3
    v_add_f32 v92, 0x358637bd, v108
    v_rcp_f32 v92, v92
    s_nop 0
    v_mul_f32 v92, v92, v6
    v_mul_f32 v96, v96, v92
    v_mul_f32 v97, v97, v92
    v_mul_f32 v98, v98, v92
    v_mul_f32 v99, v99, v92
    v_mul_f32 v100, v100, v92
    v_mul_f32 v101, v101, v92
    v_mul_f32 v102, v102, v92
    v_mul_f32 v103, v103, v92
    v_mul_f32 v104, v104, v92
    v_mul_f32 v105, v105, v92
    v_mul_f32 v106, v106, v92
    v_mul_f32 v107, v107, v92
    v_cvt_pk_bf16_f32 v48, v96, v97
    v_cvt_pk_bf16_f32 v49, v98, v99
    v_cvt_pk_bf16_f32 v50, v100, v101
    v_cvt_pk_bf16_f32 v51, v102, v103
    v_cvt_pk_bf16_f32 v52, v104, v105
    v_cvt_pk_bf16_f32 v53, v106, v107
    buffer_store_dwordx4 v[48:51], v7, s[12:15], s45 offen sc1
    s_mov_b32 exec_hi, 0
    buffer_store_dwordx2 v[52:53], v7, s[12:15], s44 offen offset:1024 sc1
    s_mov_b32 exec_hi, -1
    s_setprio 0
    s_mul_i32 s46, s67, 10240
    s_add_u32 s96, s46, s19
    s_add_u32 m0, s46, 20480
    s_add_u32 s47, s96, 40960
    buffer_load_dwordx4 v2, s[12:15], s47 offen sc1 lds
    buffer_load_dwordx4 v2, s[12:15], s47 offen offset:1024 sc1 lds
    buffer_load_dwordx4 v2, s[12:15], s47 offen offset:2048 sc1 lds
    buffer_load_dwordx4 v2, s[12:15], s47 offen offset:3072 sc1 lds
    s_add_u32 m0, s46, 24576
    s_add_u32 s47, s96, 45056
    buffer_load_dwordx4 v2, s[12:15], s47 offen sc1 lds
    buffer_load_dwordx4 v2, s[12:15], s47 offen offset:1024 sc1 lds
    buffer_load_dwordx4 v2, s[12:15], s47 offen offset:2048 sc1 lds
    buffer_load_dwordx4 v2, s[12:15], s47 offen offset:3072 sc1 lds
    s_add_u32 m0, s46, 28672
    s_add_u32 s47, s96, 49152
    buffer_load_dwordx4 v2, s[12:15], s47 offen sc1 lds
    buffer_load_dwordx4 v2, s[12:15], s47 offen offset:1024 sc1 lds
    ds_read_b128 v[8:11], v4 offset:20480
    ds_read_b128 v[12:15], v4 offset:21504
    ds_read_b128 v[16:19], v4 offset:22528
    ds_read_b128 v[20:23], v4 offset:23552
    ds_read_b128 v[24:27], v4 offset:24576
    s_barrier
    s_setprio 1
    v_mfma_f32_16x16x32_bf16 v[208:211], v[28:31], v[152:155], v[208:211]
    ds_read_b128 v[64:67], v4 offset:30720
    s_mul_i32 s40, s67, 5120
    s_add_u32 s40, s40, 0
    v_add_u32 v55, s40, v2
    s_mul_i32 s40, s67, 5120
    s_mul_i32 s41, s79, -20480
    s_add_u32 s40, s40, s41
    s_add_u32 s40, s40, 10240
    v_add_u32 v56, s40, v2
    v_mfma_f32_16x16x32_bf16 v[212:215], v[32:35], v[152:155], v[212:215]
    ds_read_b128 v[68:71], v4 offset:31744
    s_mul_i32 s40, s79, 20480
    s_add_u32 s40, s40, 122880
    v_add_u32 v57, s40, v2
    s_mul_i32 s40, s79, 5120
    s_add_u32 s40, s40, 20480
    v_add_u32 v58, s40, v2
    v_mfma_f32_16x16x32_bf16 v[216:219], v[36:39], v[152:155], v[216:219]
    ds_read_b128 v[72:75], v4 offset:32768
    s_mul_i32 s40, s79, 25600
    s_add_u32 s40, s40, 30720
    v_add_u32 v59, s40, v2
    v_and_b32 v51, 15, v1
    v_mfma_f32_16x16x32_bf16 v[220:223], v[40:43], v[152:155], v[220:223]
    ds_read_b128 v[76:79], v4 offset:33792
    v_lshlrev_b32 v50, 2, v51
    v_mul_u32_u24 v51, 1280, v51
    v_mfma_f32_16x16x32_bf16 v[224:227], v[44:47], v[152:155], v[224:227]
    ds_read_b128 v[80:83], v4 offset:34816
    v_lshrrev_b32 v53, 4, v1
    v_lshl_add_u32 v52, v53, 3, v51
    v_mfma_f32_16x16x32_bf16 v[228:231], v[28:31], v[156:159], v[228:231]
    v_and_b32 v53, 16, v1
    v_lshl_add_u32 v51, v53, 1, v51
    v_lshrrev_b32 v53, 5, v1
    v_mfma_f32_16x16x32_bf16 v[232:235], v[32:35], v[156:159], v[232:235]
    v_lshl_add_u32 v51, v53, 4, v51
    s_mov_b32 s36, s56
    s_mov_b32 s37, s57
    s_mov_b32 s38, 2621440
    s_mov_b32 s39, 0x00020000
    v_mfma_f32_16x16x32_bf16 v[236:239], v[36:39], v[156:159], v[236:239]
    v_mfma_f32_16x16x32_bf16 v[240:243], v[40:43], v[156:159], v[240:243]
    v_mfma_f32_16x16x32_bf16 v[244:247], v[44:47], v[156:159], v[244:247]
    s_waitcnt lgkmcnt(5)
    v_mfma_f32_16x16x32_bf16 v[208:211], v[8:11], v[160:163], v[208:211]
    ds_read_b128 v[28:31], v4 offset:40960
    v_mfma_f32_16x16x32_bf16 v[212:215], v[12:15], v[160:163], v[212:215]
    ds_read_b128 v[32:35], v4 offset:41984
    v_mfma_f32_16x16x32_bf16 v[216:219], v[16:19], v[160:163], v[216:219]
    ds_read_b128 v[36:39], v4 offset:43008
    v_mfma_f32_16x16x32_bf16 v[220:223], v[20:23], v[160:163], v[220:223]
    ds_read_b128 v[40:43], v4 offset:44032
    v_mfma_f32_16x16x32_bf16 v[224:227], v[24:27], v[160:163], v[224:227]
    ds_read_b128 v[44:47], v4 offset:45056
    v_mfma_f32_16x16x32_bf16 v[228:231], v[8:11], v[164:167], v[228:231]
    v_mfma_f32_16x16x32_bf16 v[232:235], v[12:15], v[164:167], v[232:235]
    v_mfma_f32_16x16x32_bf16 v[236:239], v[16:19], v[164:167], v[236:239]
    v_mfma_f32_16x16x32_bf16 v[240:243], v[20:23], v[164:167], v[240:243]
    v_mfma_f32_16x16x32_bf16 v[244:247], v[24:27], v[164:167], v[244:247]
    s_waitcnt lgkmcnt(5)
    v_mfma_f32_16x16x32_bf16 v[208:211], v[64:67], v[168:171], v[208:211]
    ds_read_b128 v[8:11], v4 offset:51200
    v_mfma_f32_16x16x32_bf16 v[212:215], v[68:71], v[168:171], v[212:215]
    ds_read_b128 v[12:15], v4 offset:52224
    v_mfma_f32_16x16x32_bf16 v[216:219], v[72:75], v[168:171], v[216:219]
    ds_read_b128 v[16:19], v4 offset:53248
    v_mfma_f32_16x16x32_bf16 v[220:223], v[76:79], v[168:171], v[220:223]
    ds_read_b128 v[20:23], v4 offset:54272
    v_mfma_f32_16x16x32_bf16 v[224:227], v[80:83], v[168:171], v[224:227]
    ds_read_b128 v[24:27], v4 offset:55296
    v_mfma_f32_16x16x32_bf16 v[228:231], v[64:67], v[172:175], v[228:231]
    v_mfma_f32_16x16x32_bf16 v[232:235], v[68:71], v[172:175], v[232:235]
    v_mfma_f32_16x16x32_bf16 v[236:239], v[72:75], v[172:175], v[236:239]
    v_mfma_f32_16x16x32_bf16 v[240:243], v[76:79], v[172:175], v[240:243]
    v_mfma_f32_16x16x32_bf16 v[244:247], v[80:83], v[172:175], v[244:247]
    s_waitcnt lgkmcnt(5)
    v_mfma_f32_16x16x32_bf16 v[208:211], v[28:31], v[176:179], v[208:211]
    ds_read_b128 v[64:67], v3 offset:10240
    v_mfma_f32_16x16x32_bf16 v[212:215], v[32:35], v[176:179], v[212:215]
    ds_read_b128 v[68:71], v3 offset:11264
    v_mfma_f32_16x16x32_bf16 v[216:219], v[36:39], v[176:179], v[216:219]
    ds_read_b128 v[72:75], v3 offset:12288
    v_mfma_f32_16x16x32_bf16 v[220:223], v[40:43], v[176:179], v[220:223]
    ds_read_b128 v[76:79], v3 offset:13312
    v_mfma_f32_16x16x32_bf16 v[224:227], v[44:47], v[176:179], v[224:227]
    ds_read_b128 v[80:83], v3 offset:14336
    v_mfma_f32_16x16x32_bf16 v[228:231], v[28:31], v[180:183], v[228:231]
    v_mfma_f32_16x16x32_bf16 v[232:235], v[32:35], v[180:183], v[232:235]
    v_mfma_f32_16x16x32_bf16 v[236:239], v[36:39], v[180:183], v[236:239]
    v_mfma_f32_16x16x32_bf16 v[240:243], v[40:43], v[180:183], v[240:243]
    v_mfma_f32_16x16x32_bf16 v[244:247], v[44:47], v[180:183], v[244:247]
    buffer_load_dwordx4 v[96:99], v0, s[12:15], s0 offen sc1
    buffer_load_dwordx4 v[100:103], v5, s[12:15], s0 offen sc1
    buffer_load_dwordx4 v[104:107], v0, s[12:15], s0 offen offset:1024 sc1
    buffer_load_dwordx4 v[108:111], v5, s[12:15], s0 offen offset:1024 sc1
    buffer_load_dwordx4 v[112:115], v0, s[12:15], s0 offen offset:2048 sc1
    buffer_load_dwordx4 v[116:119], v5, s[12:15], s0 offen offset:2048 sc1
    s_waitcnt lgkmcnt(5)
    s_waitcnt vmcnt(22)
    v_mfma_f32_16x16x32_bf16 v[208:211], v[8:11], v[184:187], v[208:211]
    ds_read_b128 v[28:31], v3 offset:0
    v_mfma_f32_16x16x32_bf16 v[212:215], v[12:15], v[184:187], v[212:215]
    ds_read_b128 v[32:35], v3 offset:1024
    v_mfma_f32_16x16x32_bf16 v[216:219], v[16:19], v[184:187], v[216:219]
    ds_read_b128 v[36:39], v3 offset:2048
    v_mfma_f32_16x16x32_bf16 v[220:223], v[20:23], v[184:187], v[220:223]
    ds_read_b128 v[40:43], v3 offset:3072
    v_mfma_f32_16x16x32_bf16 v[224:227], v[24:27], v[184:187], v[224:227]
    ds_read_b128 v[44:47], v3 offset:4096
    v_mfma_f32_16x16x32_bf16 v[228:231], v[8:11], v[188:191], v[228:231]
    v_mfma_f32_16x16x32_bf16 v[232:235], v[12:15], v[188:191], v[232:235]
    v_mfma_f32_16x16x32_bf16 v[236:239], v[16:19], v[188:191], v[236:239]
    v_mfma_f32_16x16x32_bf16 v[240:243], v[20:23], v[188:191], v[240:243]
    v_mfma_f32_16x16x32_bf16 v[244:247], v[24:27], v[188:191], v[244:247]
    s_barrier
    ds_read_b128 v[8:11], v57 offset:0
    ds_read_b128 v[12:15], v57 offset:1024
    ds_read_b128 v[16:19], v57 offset:2048
    ds_read_b128 v[20:23], v57 offset:3072
    ds_read_b128 v[24:27], v57 offset:4096
    s_cmp_eq_u32 s79, 0
    s_cbranch_scc1 L_R13_17
    s_waitcnt lgkmcnt(10)
    s_waitcnt vmcnt(20)
    v_mfma_f32_16x16x32_bf16 v[208:211], v[64:67], v[200:203], v[208:211]
    v_mfma_f32_16x16x32_bf16 v[212:215], v[68:71], v[200:203], v[212:215]
    v_mfma_f32_16x16x32_bf16 v[216:219], v[72:75], v[200:203], v[216:219]
    v_mfma_f32_16x16x32_bf16 v[220:223], v[76:79], v[200:203], v[220:223]
    v_mfma_f32_16x16x32_bf16 v[224:227], v[80:83], v[200:203], v[224:227]
    v_mfma_f32_16x16x32_bf16 v[228:231], v[64:67], v[204:207], v[228:231]
    v_mfma_f32_16x16x32_bf16 v[232:235], v[68:71], v[204:207], v[232:235]
    v_mfma_f32_16x16x32_bf16 v[236:239], v[72:75], v[204:207], v[236:239]
    v_mfma_f32_16x16x32_bf16 v[240:243], v[76:79], v[204:207], v[240:243]
    v_mfma_f32_16x16x32_bf16 v[244:247], v[80:83], v[204:207], v[244:247]
L_R13_17:
    s_waitcnt lgkmcnt(5)
    s_waitcnt vmcnt(18)
    v_mfma_f32_16x16x32_bf16 v[208:211], v[28:31], v[192:195], v[208:211]
    ds_read_b128 v[64:67], v57 offset:5120
    v_mfma_f32_16x16x32_bf16 v[212:215], v[32:35], v[192:195], v[212:215]
    ds_read_b128 v[68:71], v57 offset:6144
    buffer_load_dwordx4 v[120:123], v0, s[12:15], s0 offen offset:3072 sc1
    v_mfma_f32_16x16x32_bf16 v[216:219], v[36:39], v[192:195], v[216:219]
    ds_read_b128 v[72:75], v57 offset:7168
    v_mfma_f32_16x16x32_bf16 v[220:223], v[40:43], v[192:195], v[220:223]
    ds_read_b128 v[76:79], v57 offset:8192
    buffer_load_dwordx4 v[124:127], v5, s[12:15], s0 offen offset:3072 sc1
    v_mfma_f32_16x16x32_bf16 v[224:227], v[44:47], v[192:195], v[224:227]
    ds_read_b128 v[80:83], v57 offset:9216
    v_mfma_f32_16x16x32_bf16 v[228:231], v[28:31], v[196:199], v[228:231]
    buffer_load_dwordx4 v[128:131], v0, s[12:15], s1 offen sc1
    v_mfma_f32_16x16x32_bf16 v[232:235], v[32:35], v[196:199], v[232:235]
    v_mfma_f32_16x16x32_bf16 v[236:239], v[36:39], v[196:199], v[236:239]
    buffer_load_dwordx4 v[132:135], v5, s[12:15], s1 offen sc1
    v_mfma_f32_16x16x32_bf16 v[240:243], v[40:43], v[196:199], v[240:243]
    v_mfma_f32_16x16x32_bf16 v[244:247], v[44:47], v[196:199], v[244:247]
    buffer_load_dwordx4 v[136:139], v0, s[12:15], s30 offen sc1
    s_waitcnt vmcnt(5)
    v_max_u32 v63, v96, v98
    v_max3_u32 v63, v63, v100, v102
    v_max3_u32 v63, v63, v104, v106
    v_max3_u32 v63, v63, v108, v110
    v_max3_u32 v63, v63, v112, v114
    v_max3_u32 v63, v63, v116, v118
    v_cmp_eq_u32 vcc, -1, v63
    s_mov_b32 s76, 2000
    s_cbranch_vccz L_RD_19
L_RL_18:
    s_sleep 1
    v_max_u32 v60, v96, v98
    v_cmp_eq_u32 vcc, -1, v60
    s_nop 0
    s_mov_b64 exec, vcc
    buffer_load_dwordx4 v[96:99], v0, s[12:15], s0 offen sc1
    s_mov_b64 exec, -1
    v_max_u32 v61, v100, v102
    v_cmp_eq_u32 vcc, -1, v61
    s_nop 0
    s_mov_b64 exec, vcc
    buffer_load_dwordx4 v[100:103], v5, s[12:15], s0 offen sc1
    s_mov_b64 exec, -1
    v_max_u32 v60, v104, v106
    v_cmp_eq_u32 vcc, -1, v60
    s_nop 0
    s_mov_b64 exec, vcc
    buffer_load_dwordx4 v[104:107], v0, s[12:15], s0 offen offset:1024 sc1
    s_mov_b64 exec, -1
    v_max_u32 v61, v108, v110
    v_cmp_eq_u32 vcc, -1, v61
    s_nop 0
    s_mov_b64 exec, vcc
    buffer_load_dwordx4 v[108:111], v5, s[12:15], s0 offen offset:1024 sc1
    s_mov_b64 exec, -1
    v_max_u32 v60, v112, v114
    v_cmp_eq_u32 vcc, -1, v60
    s_nop 0
    s_mov_b64 exec, vcc
    buffer_load_dwordx4 v[112:115], v0, s[12:15], s0 offen offset:2048 sc1
    s_mov_b64 exec, -1
    v_max_u32 v61, v116, v118
    v_cmp_eq_u32 vcc, -1, v61
    s_nop 0
    s_mov_b64 exec, vcc
    buffer_load_dwordx4 v[116:119], v5, s[12:15], s0 offen offset:2048 sc1
    s_mov_b64 exec, -1
    s_waitcnt vmcnt(0)
    s_sub_u32 s76, s76, 1
    s_cmp_eq_u32 s76, 0
    s_cbranch_scc1 L_RD_19
    v_max_u32 v63, v96, v98
    v_max3_u32 v63, v63, v100, v102
    v_max3_u32 v63, v63, v104, v106
    v_max3_u32 v63, v63, v108, v110
    v_max3_u32 v63, v63, v112, v114
    v_max3_u32 v63, v63, v116, v118
    v_cmp_eq_u32 vcc, -1, v63
    s_cbranch_vccnz L_RL_18
L_RD_19:
    s_waitcnt lgkmcnt(5)
    v_mfma_f32_16x16x32_bf16 v[208:211], v[8:11], v[96:99], v[208:211]
    ds_read_b128 v[28:31], v57 offset:10240
    v_mfma_f32_16x16x32_bf16 v[212:215], v[12:15], v[96:99], v[212:215]
    ds_read_b128 v[32:35], v57 offset:11264
    buffer_load_dwordx4 v[140:143], v5, s[12:15], s30 offen sc1
    v_mfma_f32_16x16x32_bf16 v[216:219], v[16:19], v[96:99], v[216:219]
    ds_read_b128 v[36:39], v57 offset:12288
    v_mfma_f32_16x16x32_bf16 v[220:223], v[20:23], v[96:99], v[220:223]
    ds_read_b128 v[40:43], v57 offset:13312
    buffer_load_dwordx4 v[144:147], v0, s[12:15], s30 offen offset:1024 sc1
    v_mfma_f32_16x16x32_bf16 v[224:227], v[24:27], v[96:99], v[224:227]
    ds_read_b128 v[44:47], v57 offset:14336
    v_mfma_f32_16x16x32_bf16 v[228:231], v[8:11], v[100:103], v[228:231]
    buffer_load_dwordx4 v[148:151], v5, s[12:15], s30 offen offset:1024 sc1
    v_mfma_f32_16x16x32_bf16 v[232:235], v[12:15], v[100:103], v[232:235]
    v_mfma_f32_16x16x32_bf16 v[236:239], v[16:19], v[100:103], v[236:239]
    buffer_load_dwordx4 v[152:155], v0, s[12:15], s30 offen offset:2048 sc1
    v_mfma_f32_16x16x32_bf16 v[240:243], v[20:23], v[100:103], v[240:243]
    v_mfma_f32_16x16x32_bf16 v[244:247], v[24:27], v[100:103], v[244:247]
    buffer_load_dwordx4 v[156:159], v5, s[12:15], s30 offen offset:2048 sc1
    s_waitcnt lgkmcnt(5)
    v_mfma_f32_16x16x32_bf16 v[208:211], v[64:67], v[104:107], v[208:211]
    ds_read_b128 v[8:11], v57 offset:15360
    v_mfma_f32_16x16x32_bf16 v[212:215], v[68:71], v[104:107], v[212:215]
    ds_read_b128 v[12:15], v57 offset:16384
    buffer_load_dwordx4 v[160:163], v0, s[12:15], s30 offen offset:3072 sc1
    v_mfma_f32_16x16x32_bf16 v[216:219], v[72:75], v[104:107], v[216:219]
    ds_read_b128 v[16:19], v57 offset:17408
    v_mfma_f32_16x16x32_bf16 v[220:223], v[76:79], v[104:107], v[220:223]
    ds_read_b128 v[20:23], v57 offset:18432
    buffer_load_dwordx4 v[164:167], v5, s[12:15], s30 offen offset:3072 sc1
    v_mfma_f32_16x16x32_bf16 v[224:227], v[80:83], v[104:107], v[224:227]
    ds_read_b128 v[24:27], v57 offset:19456
    v_mfma_f32_16x16x32_bf16 v[228:231], v[64:67], v[108:111], v[228:231]
    s_add_u32 s98, s30, 4096
    buffer_load_dwordx4 v[168:171], v0, s[12:15], s98 offen sc1
    v_mfma_f32_16x16x32_bf16 v[232:235], v[68:71], v[108:111], v[232:235]
    v_mfma_f32_16x16x32_bf16 v[236:239], v[72:75], v[108:111], v[236:239]
    s_add_u32 s98, s30, 4096
    buffer_load_dwordx4 v[172:175], v5, s[12:15], s98 offen sc1
    v_mfma_f32_16x16x32_bf16 v[240:243], v[76:79], v[108:111], v[240:243]
    v_mfma_f32_16x16x32_bf16 v[244:247], v[80:83], v[108:111], v[244:247]
    s_barrier
    s_waitcnt lgkmcnt(5)
    v_mfma_f32_16x16x32_bf16 v[208:211], v[28:31], v[112:115], v[208:211]
    ds_read_b128 v[64:67], v58 offset:0
    v_mfma_f32_16x16x32_bf16 v[212:215], v[32:35], v[112:115], v[212:215]
    ds_read_b128 v[68:71], v58 offset:1024
    v_mfma_f32_16x16x32_bf16 v[216:219], v[36:39], v[112:115], v[216:219]
    ds_read_b128 v[72:75], v58 offset:2048
    v_mfma_f32_16x16x32_bf16 v[220:223], v[40:43], v[112:115], v[220:223]
    ds_read_b128 v[76:79], v58 offset:3072
    v_mfma_f32_16x16x32_bf16 v[224:227], v[44:47], v[112:115], v[224:227]
    ds_read_b128 v[80:83], v58 offset:4096
    v_mfma_f32_16x16x32_bf16 v[228:231], v[28:31], v[116:119], v[228:231]
    v_mfma_f32_16x16x32_bf16 v[232:235], v[32:35], v[116:119], v[232:235]
    v_mfma_f32_16x16x32_bf16 v[236:239], v[36:39], v[116:119], v[236:239]
    v_mfma_f32_16x16x32_bf16 v[240:243], v[40:43], v[116:119], v[240:243]
    v_mfma_f32_16x16x32_bf16 v[244:247], v[44:47], v[116:119], v[244:247]
    s_waitcnt vmcnt(8)
    v_max_u32 v63, v120, v122
    v_max3_u32 v63, v63, v124, v126
    v_max3_u32 v63, v63, v128, v130
    v_max3_u32 v63, v63, v132, v134
    v_max3_u32 v63, v63, v136, v138
    v_max3_u32 v63, v63, v140, v142
    v_cmp_eq_u32 vcc, -1, v63
    s_mov_b32 s76, 2000
    s_cbranch_vccz L_RD_21
L_RL_20:
    s_sleep 1
    v_max_u32 v60, v120, v122
    v_cmp_eq_u32 vcc, -1, v60
    s_nop 0
    s_mov_b64 exec, vcc
    buffer_load_dwordx4 v[120:123], v0, s[12:15], s0 offen offset:3072 sc1
    s_mov_b64 exec, -1
    v_max_u32 v61, v124, v126
    v_cmp_eq_u32 vcc, -1, v61
    s_nop 0
    s_mov_b64 exec, vcc
    buffer_load_dwordx4 v[124:127], v5, s[12:15], s0 offen offset:3072 sc1
    s_mov_b64 exec, -1
    v_max_u32 v60, v128, v130
    v_cmp_eq_u32 vcc, -1, v60
    s_nop 0
    s_mov_b64 exec, vcc
    buffer_load_dwordx4 v[128:131], v0, s[12:15], s1 offen sc1
    s_mov_b64 exec, -1
    v_max_u32 v61, v132, v134
    v_cmp_eq_u32 vcc, -1, v61
    s_nop 0
    s_mov_b64 exec, vcc
    buffer_load_dwordx4 v[132:135], v5, s[12:15], s1 offen sc1
    s_mov_b64 exec, -1
    v_max_u32 v60, v136, v138
    v_cmp_eq_u32 vcc, -1, v60
    s_nop 0
    s_mov_b64 exec, vcc
    buffer_load_dwordx4 v[136:139], v0, s[12:15], s30 offen sc1
    s_mov_b64 exec, -1
    v_max_u32 v61, v140, v142
    v_cmp_eq_u32 vcc, -1, v61
    s_nop 0
    s_mov_b64 exec, vcc
    buffer_load_dwordx4 v[140:143], v5, s[12:15], s30 offen sc1
    s_mov_b64 exec, -1
    s_waitcnt vmcnt(0)
    s_sub_u32 s76, s76, 1
    s_cmp_eq_u32 s76, 0
    s_cbranch_scc1 L_RD_21
    v_max_u32 v63, v120, v122
    v_max3_u32 v63, v63, v124, v126
    v_max3_u32 v63, v63, v128, v130
    v_max3_u32 v63, v63, v132, v134
    v_max3_u32 v63, v63, v136, v138
    v_max3_u32 v63, v63, v140, v142
    v_cmp_eq_u32 vcc, -1, v63
    s_cbranch_vccnz L_RL_20
L_RD_21:
    s_waitcnt lgkmcnt(5)
    v_mfma_f32_16x16x32_bf16 v[208:211], v[8:11], v[120:123], v[208:211]
    ds_read_b128 v[28:31], v59 offset:0
    v_mfma_f32_16x16x32_bf16 v[212:215], v[12:15], v[120:123], v[212:215]
    ds_read_b128 v[32:35], v59 offset:1024
    v_mfma_f32_16x16x32_bf16 v[216:219], v[16:19], v[120:123], v[216:219]
    ds_read_b128 v[36:39], v59 offset:2048
    v_mfma_f32_16x16x32_bf16 v[220:223], v[20:23], v[120:123], v[220:223]
    ds_read_b128 v[40:43], v59 offset:3072
    v_mfma_f32_16x16x32_bf16 v[224:227], v[24:27], v[120:123], v[224:227]
    ds_read_b128 v[44:47], v59 offset:4096
    v_mfma_f32_16x16x32_bf16 v[228:231], v[8:11], v[124:127], v[228:231]
    v_mfma_f32_16x16x32_bf16 v[232:235], v[12:15], v[124:127], v[232:235]
    v_mfma_f32_16x16x32_bf16 v[236:239], v[16:19], v[124:127], v[236:239]
    v_mfma_f32_16x16x32_bf16 v[240:243], v[20:23], v[124:127], v[240:243]
    v_mfma_f32_16x16x32_bf16 v[244:247], v[24:27], v[124:127], v[244:247]
    s_waitcnt lgkmcnt(5)
    v_mfma_f32_16x16x32_bf16 v[208:211], v[64:67], v[128:131], v[208:211]
    ds_read_b128 v[8:11], v59 offset:5120
    v_mfma_f32_16x16x32_bf16 v[212:215], v[68:71], v[128:131], v[212:215]
    ds_read_b128 v[12:15], v59 offset:6144
    buffer_load_dword v48, v50, s[12:15], s97 offen sc1
    v_mfma_f32_16x16x32_bf16 v[216:219], v[72:75], v[128:131], v[216:219]
    ds_read_b128 v[16:19], v59 offset:7168
    v_mfma_f32_16x16x32_bf16 v[220:223], v[76:79], v[128:131], v[220:223]
    ds_read_b128 v[20:23], v59 offset:8192
    buffer_load_dwordx4 v[176:179], v2, s[12:15], s49 offen sc1
    v_mfma_f32_16x16x32_bf16 v[224:227], v[80:83], v[128:131], v[224:227]
    ds_read_b128 v[24:27], v59 offset:9216
    v_mfma_f32_16x16x32_bf16 v[228:231], v[64:67], v[132:135], v[228:231]
    buffer_load_dwordx4 v[180:183], v2, s[12:15], s49 offen offset:1024 sc1
    v_mfma_f32_16x16x32_bf16 v[232:235], v[68:71], v[132:135], v[232:235]
    v_mfma_f32_16x16x32_bf16 v[236:239], v[72:75], v[132:135], v[236:239]
    buffer_load_dwordx4 v[184:187], v2, s[12:15], s49 offen offset:2048 sc1
    v_mfma_f32_16x16x32_bf16 v[240:243], v[76:79], v[132:135], v[240:243]
    v_mfma_f32_16x16x32_bf16 v[244:247], v[80:83], v[132:135], v[244:247]
    buffer_load_dwordx4 v[188:191], v2, s[12:15], s49 offen offset:3072 sc1
    s_waitcnt lgkmcnt(5)
    v_mfma_f32_16x16x32_bf16 v[208:211], v[28:31], v[136:139], v[208:211]
    ds_read_b128 v[64:67], v59 offset:10240
    v_mfma_f32_16x16x32_bf16 v[212:215], v[32:35], v[136:139], v[212:215]
    ds_read_b128 v[68:71], v59 offset:11264
    s_add_u32 s98, s49, 4096
    buffer_load_dwordx4 v[192:195], v2, s[12:15], s98 offen sc1
    v_mfma_f32_16x16x32_bf16 v[216:219], v[36:39], v[136:139], v[216:219]
    ds_read_b128 v[72:75], v59 offset:12288
    v_mfma_f32_16x16x32_bf16 v[220:223], v[40:43], v[136:139], v[220:223]
    ds_read_b128 v[76:79], v59 offset:13312
    v_mfma_f32_16x16x32_bf16 v[224:227], v[44:47], v[136:139], v[224:227]
    ds_read_b128 v[80:83], v59 offset:14336
    v_mfma_f32_16x16x32_bf16 v[228:231], v[28:31], v[140:143], v[228:231]
    v_mfma_f32_16x16x32_bf16 v[232:235], v[32:35], v[140:143], v[232:235]
    v_mfma_f32_16x16x32_bf16 v[236:239], v[36:39], v[140:143], v[236:239]
    v_mfma_f32_16x16x32_bf16 v[240:243], v[40:43], v[140:143], v[240:243]
    v_mfma_f32_16x16x32_bf16 v[244:247], v[44:47], v[140:143], v[244:247]
    s_waitcnt vmcnt(6)
    v_max_u32 v63, v144, v146
    v_max3_u32 v63, v63, v148, v150
    v_max3_u32 v63, v63, v152, v154
    v_max3_u32 v63, v63, v156, v158
    v_max3_u32 v63, v63, v160, v162
    v_max3_u32 v63, v63, v164, v166
    v_max3_u32 v63, v63, v168, v170
    v_max3_u32 v63, v63, v172, v174
    v_cmp_eq_u32 vcc, -1, v63
    s_mov_b32 s76, 2000
    s_cbranch_vccz L_RD_23
L_RL_22:
    s_sleep 1
    v_max_u32 v60, v144, v146
    v_cmp_eq_u32 vcc, -1, v60
    s_nop 0
    s_mov_b64 exec, vcc
    buffer_load_dwordx4 v[144:147], v0, s[12:15], s30 offen offset:1024 sc1
    s_mov_b64 exec, -1
    v_max_u32 v61, v148, v150
    v_cmp_eq_u32 vcc, -1, v61
    s_nop 0
    s_mov_b64 exec, vcc
    buffer_load_dwordx4 v[148:151], v5, s[12:15], s30 offen offset:1024 sc1
    s_mov_b64 exec, -1
    v_max_u32 v60, v152, v154
    v_cmp_eq_u32 vcc, -1, v60
    s_nop 0
    s_mov_b64 exec, vcc
    buffer_load_dwordx4 v[152:155], v0, s[12:15], s30 offen offset:2048 sc1
    s_mov_b64 exec, -1
    v_max_u32 v61, v156, v158
    v_cmp_eq_u32 vcc, -1, v61
    s_nop 0
    s_mov_b64 exec, vcc
    buffer_load_dwordx4 v[156:159], v5, s[12:15], s30 offen offset:2048 sc1
    s_mov_b64 exec, -1
    v_max_u32 v60, v160, v162
    v_cmp_eq_u32 vcc, -1, v60
    s_nop 0
    s_mov_b64 exec, vcc
    buffer_load_dwordx4 v[160:163], v0, s[12:15], s30 offen offset:3072 sc1
    s_mov_b64 exec, -1
    v_max_u32 v61, v164, v166
    v_cmp_eq_u32 vcc, -1, v61
    s_nop 0
    s_mov_b64 exec, vcc
    buffer_load_dwordx4 v[164:167], v5, s[12:15], s30 offen offset:3072 sc1
    s_mov_b64 exec, -1
    v_max_u32 v60, v168, v170
    v_cmp_eq_u32 vcc, -1, v60
    s_nop 0
    s_mov_b64 exec, vcc
    s_add_u32 s98, s30, 4096
    buffer_load_dwordx4 v[168:171], v0, s[12:15], s98 offen sc1
    s_mov_b64 exec, -1
    v_max_u32 v61, v172, v174
    v_cmp_eq_u32 vcc, -1, v61
    s_nop 0
    s_mov_b64 exec, vcc
    s_add_u32 s98, s30, 4096
    buffer_load_dwordx4 v[172:175], v5, s[12:15], s98 offen sc1
    s_mov_b64 exec, -1
    s_waitcnt vmcnt(0)
    s_sub_u32 s76, s76, 1
    s_cmp_eq_u32 s76, 0
    s_cbranch_scc1 L_RD_23
    v_max_u32 v63, v144, v146
    v_max3_u32 v63, v63, v148, v150
    v_max3_u32 v63, v63, v152, v154
    v_max3_u32 v63, v63, v156, v158
    v_max3_u32 v63, v63, v160, v162
    v_max3_u32 v63, v63, v164, v166
    v_max3_u32 v63, v63, v168, v170
    v_max3_u32 v63, v63, v172, v174
    v_cmp_eq_u32 vcc, -1, v63
    s_cbranch_vccnz L_RL_22
L_RD_23:
    s_waitcnt lgkmcnt(5)
    v_mfma_f32_16x16x32_bf16 v[208:211], v[8:11], v[144:147], v[208:211]
    ds_read_b128 v[28:31], v59 offset:15360
    v_mfma_f32_16x16x32_bf16 v[212:215], v[12:15], v[144:147], v[212:215]
    ds_read_b128 v[32:35], v59 offset:16384
    v_mfma_f32_16x16x32_bf16 v[216:219], v[16:19], v[144:147], v[216:219]
    ds_read_b128 v[36:39], v59 offset:17408
    v_mfma_f32_16x16x32_bf16 v[220:223], v[20:23], v[144:147], v[220:223]
    ds_read_b128 v[40:43], v59 offset:18432
    v_mfma_f32_16x16x32_bf16 v[224:227], v[24:27], v[144:147], v[224:227]
    ds_read_b128 v[44:47], v59 offset:19456
    v_mfma_f32_16x16x32_bf16 v[228:231], v[8:11], v[148:151], v[228:231]
    v_mfma_f32_16x16x32_bf16 v[232:235], v[12:15], v[148:151], v[232:235]
    v_mfma_f32_16x16x32_bf16 v[236:239], v[16:19], v[148:151], v[236:239]
    v_mfma_f32_16x16x32_bf16 v[240:243], v[20:23], v[148:151], v[240:243]
    v_mfma_f32_16x16x32_bf16 v[244:247], v[24:27], v[148:151], v[244:247]
    s_waitcnt lgkmcnt(5)
    v_mfma_f32_16x16x32_bf16 v[208:211], v[64:67], v[152:155], v[208:211]
    ds_read_b128 v[8:11], v59 offset:20480
    v_mfma_f32_16x16x32_bf16 v[212:215], v[68:71], v[152:155], v[212:215]
    ds_read_b128 v[12:15], v59 offset:21504
    v_mfma_f32_16x16x32_bf16 v[216:219], v[72:75], v[152:155], v[216:219]
    ds_read_b128 v[16:19], v59 offset:22528
    v_mfma_f32_16x16x32_bf16 v[220:223], v[76:79], v[152:155], v[220:223]
    ds_read_b128 v[20:23], v59 offset:23552
    v_mfma_f32_16x16x32_bf16 v[224:227], v[80:83], v[152:155], v[224:227]
    ds_read_b128 v[24:27], v59 offset:24576
    v_mfma_f32_16x16x32_bf16 v[228:231], v[64:67], v[156:159], v[228:231]
    v_mfma_f32_16x16x32_bf16 v[232:235], v[68:71], v[156:159], v[232:235]
    v_mfma_f32_16x16x32_bf16 v[236:239], v[72:75], v[156:159], v[236:239]
    v_mfma_f32_16x16x32_bf16 v[240:243], v[76:79], v[156:159], v[240:243]
    v_mfma_f32_16x16x32_bf16 v[244:247], v[80:83], v[156:159], v[244:247]
    s_waitcnt vmcnt(5)
    v_cmp_eq_u32 vcc, -1, v48
    s_mov_b32 s76, 2000
    s_cbranch_vccz L_RD_25
L_RL_24:
    s_sleep 1
    buffer_load_dword v48, v50, s[12:15], s97 offen sc1
    s_waitcnt vmcnt(0)
    s_sub_u32 s76, s76, 1
    s_cmp_eq_u32 s76, 0
    s_cbranch_scc1 L_RD_25
    v_cmp_eq_u32 vcc, -1, v48
    s_cbranch_vccnz L_RL_24
L_RD_25:
    s_waitcnt vmcnt(4)
    v_perm_b32 v61, v178, v176, s3
    v_sad_u32 v60, v61, s53, 0
    s_waitcnt vmcnt(3)
    v_perm_b32 v62, v182, v180, s3
    v_sad_u32 v60, v62, s53, v60
    s_waitcnt vmcnt(2)
    v_perm_b32 v61, v186, v184, s3
    v_sad_u32 v60, v61, s53, v60
    s_waitcnt vmcnt(1)
    v_perm_b32 v62, v190, v188, s3
    v_sad_u32 v60, v62, s53, v60
    s_waitcnt vmcnt(0)
    v_perm_b32 v61, v194, v192, s3
    v_sad_u32 v60, v61, s53, v60
    v_cmp_ne_u32 vcc, 0, v60
    s_mov_b32 s76, 2000
    s_cbranch_vccz L_RD_27
L_RL_26:
    s_sleep 1
    buffer_load_dwordx4 v[176:179], v2, s[12:15], s49 offen sc1
    buffer_load_dwordx4 v[180:183], v2, s[12:15], s49 offen offset:1024 sc1
    buffer_load_dwordx4 v[184:187], v2, s[12:15], s49 offen offset:2048 sc1
    buffer_load_dwordx4 v[188:191], v2, s[12:15], s49 offen offset:3072 sc1
    s_add_u32 s98, s49, 4096
    buffer_load_dwordx4 v[192:195], v2, s[12:15], s98 offen sc1
    s_waitcnt vmcnt(0)
    s_sub_u32 s76, s76, 1
    s_cmp_eq_u32 s76, 0
    s_cbranch_scc1 L_RD_27
    v_perm_b32 v61, v178, v176, s3
    v_sad_u32 v60, v61, s53, 0
    v_perm_b32 v62, v182, v180, s3
    v_sad_u32 v60, v62, s53, v60
    v_perm_b32 v61, v186, v184, s3
    v_sad_u32 v60, v61, s53, v60
    v_perm_b32 v62, v190, v188, s3
    v_sad_u32 v60, v62, s53, v60
    v_perm_b32 v61, v194, v192, s3
    v_sad_u32 v60, v61, s53, v60
    v_cmp_ne_u32 vcc, 0, v60
    s_cbranch_vccnz L_RL_26
L_RD_27:
    s_waitcnt lgkmcnt(5)
    v_mfma_f32_16x16x32_bf16 v[208:211], v[28:31], v[160:163], v[208:211]
    v_mul_f32 v176, v176, v48
    v_mul_f32 v177, v177, v48
    v_mfma_f32_16x16x32_bf16 v[212:215], v[32:35], v[160:163], v[212:215]
    v_mul_f32 v178, v178, v48
    v_mul_f32 v179, v179, v48
    v_mfma_f32_16x16x32_bf16 v[216:219], v[36:39], v[160:163], v[216:219]
    v_mul_f32 v180, v180, v48
    v_mul_f32 v181, v181, v48
    v_mfma_f32_16x16x32_bf16 v[220:223], v[40:43], v[160:163], v[220:223]
    v_mul_f32 v182, v182, v48
    v_mul_f32 v183, v183, v48
    v_mfma_f32_16x16x32_bf16 v[224:227], v[44:47], v[160:163], v[224:227]
    v_mul_f32 v184, v184, v48
    v_mul_f32 v185, v185, v48
    v_mfma_f32_16x16x32_bf16 v[228:231], v[28:31], v[164:167], v[228:231]
    v_mul_f32 v186, v186, v48
    v_mul_f32 v187, v187, v48
    v_mfma_f32_16x16x32_bf16 v[232:235], v[32:35], v[164:167], v[232:235]
    v_mul_f32 v188, v188, v48
    v_mul_f32 v189, v189, v48
    v_mfma_f32_16x16x32_bf16 v[236:239], v[36:39], v[164:167], v[236:239]
    v_mul_f32 v190, v190, v48
    v_mul_f32 v191, v191, v48
    v_mfma_f32_16x16x32_bf16 v[240:243], v[40:43], v[164:167], v[240:243]
    v_mul_f32 v192, v192, v48
    v_mul_f32 v193, v193, v48
    v_mfma_f32_16x16x32_bf16 v[244:247], v[44:47], v[164:167], v[244:247]
    v_mul_f32 v194, v194, v48
    v_mul_f32 v195, v195, v48
    s_waitcnt lgkmcnt(0)
    v_mfma_f32_16x16x32_bf16 v[228:231], v[8:11], v[172:175], v[228:231]
    v_mfma_f32_16x16x32_bf16 v[232:235], v[12:15], v[172:175], v[232:235]
    v_mfma_f32_16x16x32_bf16 v[236:239], v[16:19], v[172:175], v[236:239]
    s_nop 5
    ds_write_b128 v55, v[228:231] offset:0
    v_mfma_f32_16x16x32_bf16 v[240:243], v[20:23], v[172:175], v[240:243]
    ds_write_b128 v55, v[232:235] offset:1024
    v_mfma_f32_16x16x32_bf16 v[244:247], v[24:27], v[172:175], v[244:247]
    ds_write_b128 v55, v[236:239] offset:2048
    v_mfma_f32_16x16x32_bf16 v[208:211], v[8:11], v[168:171], v[208:211]
    s_nop 3
    ds_write_b128 v55, v[240:243] offset:3072
    v_mfma_f32_16x16x32_bf16 v[212:215], v[12:15], v[168:171], v[212:215]
    ds_write_b128 v55, v[244:247] offset:4096
    v_mfma_f32_16x16x32_bf16 v[216:219], v[16:19], v[168:171], v[216:219]
    v_mfma_f32_16x16x32_bf16 v[220:223], v[20:23], v[168:171], v[220:223]
    v_mfma_f32_16x16x32_bf16 v[224:227], v[24:27], v[168:171], v[224:227]
    s_waitcnt lgkmcnt(0)
    s_barrier
    ds_read_b128 v[136:139], v56 offset:0
    ds_read_b128 v[140:143], v56 offset:1024
    ds_read_b128 v[144:147], v56 offset:2048
    ds_read_b128 v[148:151], v56 offset:3072
    ds_read_b128 v[152:155], v56 offset:4096
    v_pk_fma_f32 v[208:209], v[208:209], v[48:49], v[176:177] op_sel_hi:[1,0,1]
    v_pk_fma_f32 v[210:211], v[210:211], v[48:49], v[178:179] op_sel_hi:[1,0,1]
    v_pk_fma_f32 v[212:213], v[212:213], v[48:49], v[180:181] op_sel_hi:[1,0,1]
    v_pk_fma_f32 v[214:215], v[214:215], v[48:49], v[182:183] op_sel_hi:[1,0,1]
    v_pk_fma_f32 v[216:217], v[216:217], v[48:49], v[184:185] op_sel_hi:[1,0,1]
    v_pk_fma_f32 v[218:219], v[218:219], v[48:49], v[186:187] op_sel_hi:[1,0,1]
    v_pk_fma_f32 v[220:221], v[220:221], v[48:49], v[188:189] op_sel_hi:[1,0,1]
    v_pk_fma_f32 v[222:223], v[222:223], v[48:49], v[190:191] op_sel_hi:[1,0,1]
    v_pk_fma_f32 v[224:225], v[224:225], v[48:49], v[192:193] op_sel_hi:[1,0,1]
    v_pk_fma_f32 v[226:227], v[226:227], v[48:49], v[194:195] op_sel_hi:[1,0,1]
    s_waitcnt lgkmcnt(4)
    v_pk_fma_f32 v[208:209], v[136:137], v[48:49], v[208:209] op_sel_hi:[1,0,1]
    v_pk_fma_f32 v[210:211], v[138:139], v[48:49], v[210:211] op_sel_hi:[1,0,1]
    s_waitcnt lgkmcnt(3)
    v_pk_fma_f32 v[212:213], v[140:141], v[48:49], v[212:213] op_sel_hi:[1,0,1]
    v_pk_fma_f32 v[214:215], v[142:143], v[48:49], v[214:215] op_sel_hi:[1,0,1]
    v_cvt_pk_bf16_f32 v160, v208, v209
    v_cvt_pk_bf16_f32 v161, v210, v211
    v_cvt_pk_bf16_f32 v162, v212, v213
    v_cvt_pk_bf16_f32 v163, v214, v215
    s_nop 0
    v_permlane16_swap_b32 v160, v162
    v_permlane16_swap_b32 v161, v163
    buffer_store_dwordx4 v[160:163], v51, s[36:39], s48 offen
    s_waitcnt lgkmcnt(2)
    v_pk_fma_f32 v[216:217], v[144:145], v[48:49], v[216:217] op_sel_hi:[1,0,1]
    v_pk_fma_f32 v[218:219], v[146:147], v[48:49], v[218:219] op_sel_hi:[1,0,1]
    s_waitcnt lgkmcnt(1)
    v_pk_fma_f32 v[220:221], v[148:149], v[48:49], v[220:221] op_sel_hi:[1,0,1]
    v_pk_fma_f32 v[222:223], v[150:151], v[48:49], v[222:223] op_sel_hi:[1,0,1]
    v_cvt_pk_bf16_f32 v164, v216, v217
    v_cvt_pk_bf16_f32 v165, v218, v219
    v_cvt_pk_bf16_f32 v166, v220, v221
    v_cvt_pk_bf16_f32 v167, v222, v223
    s_nop 0
    v_permlane16_swap_b32 v164, v166
    v_permlane16_swap_b32 v165, v167
    buffer_store_dwordx4 v[164:167], v51, s[36:39], s48 offen offset:64
    s_waitcnt lgkmcnt(0)
    v_pk_fma_f32 v[224:225], v[152:153], v[48:49], v[224:225] op_sel_hi:[1,0,1]
    v_pk_fma_f32 v[226:227], v[154:155], v[48:49], v[226:227] op_sel_hi:[1,0,1]
    v_cvt_pk_bf16_f32 v168, v224, v225
    v_cvt_pk_bf16_f32 v169, v226, v227
    buffer_store_dwordx2 v[168:169], v52, s[36:39], s48 offen offset:128
    s_or_b32 s40, s2, s67
    s_cmp_eq_u32 s40, 0
    s_cselect_b32 s40, 0, s101
    v_mov_b32 v60, s100
    v_lshlrev_b32 v61, 2, v1
    s_cmp_eq_u32 s40, s101
    s_cselect_b32 exec_lo, 0, -1
    s_mov_b32 exec_hi, 0
    buffer_store_dword v60, v61, s[12:15], s40 offen sc1
    s_mov_b64 exec, -1
    s_waitcnt vmcnt(0)
L_END:
    s_endpgm
.section .rodata,"a"
.p2align 6
.amdhsa_kernel gated_mix__linear_kernel_hedgehog__dense_activation_silu__prompt_kernel
  .amdhsa_next_free_vgpr 256
  .amdhsa_next_free_sgpr 102
  .amdhsa_accum_offset 256
  .amdhsa_group_segment_fixed_size 0
  .amdhsa_kernarg_size 88
  .amdhsa_user_sgpr_count 2
  .amdhsa_user_sgpr_kernarg_segment_ptr 1
  .amdhsa_system_sgpr_workgroup_id_x 1
.end_amdhsa_kernel
```
